```python
import torch

def _softmax(x, axis=-1):
    return torch.softmax(x, dim=axis)
def _gelu(x):
    return torch.nn.functional.gelu(x, approximate="tanh")
def _silu(x):
    return torch.nn.functional.silu(x)
def _sigmoid(x):
    return torch.sigmoid(x)
def _layernorm(x, axis=-1, eps=1e-5):
    m = x.mean(dim=axis, keepdim=True)
    v = x.var(dim=axis, keepdim=True, unbiased=False)
    return (x - m) / torch.sqrt(v + eps)
def _scatter_add(tgt, idx, src, axis=0):
    return tgt.clone().index_add_(axis, idx, src)
def _segment_sum(src, seg, n):
    out = torch.zeros((n,) + src.shape[1:], dtype=src.dtype)
    return out.index_add_(0, seg, src)
def _pad(x, pw):
    flat = tuple(v for pair in reversed(pw) for v in pair)
    return torch.nn.functional.pad(x, flat)

kernel_name = 'concat_heads__linear_attn_block__sliding_local_dilated__prompt'

def setup_inputs():

    _w = (lambda a: (lambda t: t.to(torch.bfloat16) if t.is_floating_point() else t)(torch.as_tensor(a)))
    def _A_setup():
        B, S, D = 1, 2048, 512
        return {
            "x": _w((lambda *s: torch.randn(*s, dtype=torch.bfloat16) * 0.05)(B, S, D)),
            "wqkv": _w((lambda *s: torch.randn(*s, dtype=torch.bfloat16) * 1.6)(D, 3 * D)),
            "wo": _w((lambda *s: torch.randn(*s, dtype=torch.bfloat16) * 0.8)(D, D)),
        }
    _A_in = _A_setup()

    def _B_setup():
        B, S, D = 1, 2048, 512
        return {
            "x": _w((lambda *s: torch.randn(*s, dtype=torch.bfloat16) * 0.2)(B, S, D)),
            "wqkv": _w((lambda *s: torch.randn(*s, dtype=torch.bfloat16) * 0.2)(D, 3 * D)),
            "wo": _w((lambda *s: torch.randn(*s, dtype=torch.bfloat16) * 0.05)(D, D)),
        }
    _B_in = _B_setup()

    return {
        "A_x": _A_in["x"],
        "A_wqkv": _A_in["wqkv"],
        "A_wo": _A_in["wo"],
        "B_x": _B_in["x"],
        "B_wqkv": _B_in["wqkv"],
        "B_wo": _B_in["wo"],
    }

def reference(A_x, A_wqkv, A_wo, B_x, B_wqkv, B_wo):
    def _A_ref(x, wqkv, wo):
        B, S, D = x.shape
        H = 32; Dh = D // H
        qkv = (lambda x, *d: x.permute(*d))((x @ wqkv).reshape(B, S, 3, H, Dh), 2, 0, 3, 1, 4)
        q, k, v = qkv[0], qkv[1], qkv[2]
        phi = lambda t: torch.where(t > 0, t + 1, torch.exp(t)) + 1e-6
        pq, pk = phi(q), phi(k)
        kv = torch.einsum("bhsd,bhse->bhde", pk, v)
        z = torch.einsum("bhsd->bhd", pk)
        num = torch.einsum("bhqd,bhde->bhqe", pq, kv)
        den = torch.einsum("bhqd,bhd->bhq", pq, z)[..., None] + 1e-6
        o = num / den
        return (lambda x, *d: x.permute(*d))(o, 0, 2, 1, 3).reshape(B, S, D) @ wo

    def _B_ref(x, wqkv, wo):
        B, S, D = x.shape
        H = 32; Dh = D // H
        W, dil = 8, 2
        qkv = (lambda x, *d: x.permute(*d))((x @ wqkv).reshape(B, S, 3, H, Dh), 2, 0, 3, 1, 4)
        q, k, v = qkv[0], qkv[1], qkv[2]
        scale = Dh ** -0.5
        pos = torch.arange(S)
        off = torch.arange(W) * dil
        idx = pos[:, None] - off[None, :]
        mask = idx >= 0
        idx_c = torch.where(mask, idx, 0).reshape(-1)
        kg = k[:, :, idx_c, :].reshape(B, H, S, W, Dh)
        vg = v[:, :, idx_c, :].reshape(B, H, S, W, Dh)
        logits = torch.einsum("bhsd,bhswd->bhsw", q, kg) * scale
        logits = torch.where(mask[None, None, :, :], logits, -1e9)
        attn = _softmax(logits, axis=-1)
        o = torch.einsum("bhsw,bhswd->bhsd", attn, vg)
        return (lambda x, *d: x.permute(*d))(o, 0, 2, 1, 3).reshape(B, S, D) @ wo

    a = _A_ref(A_x, A_wqkv, A_wo)
    b = _B_ref(B_x, B_wqkv, B_wo)
    return torch.concatenate([a, b], axis=-1)
```

```asm
; @launch grid=(256,1,1) block=(512,1,1) lds=163840
.amdgcn_target "amdgcn-amd-amdhsa--gfx950"
.text
.globl concat_heads__linear_attn_block__sliding_local_dilated__prompt_kernel
.p2align 8
.type concat_heads__linear_attn_block__sliding_local_dilated__prompt_kernel,@function
concat_heads__linear_attn_block__sliding_local_dilated__prompt_kernel:
    s_cmp_ge_u32 s2, 256
    s_cbranch_scc1 L_end
    s_and_b32 s52, s2, 7
    s_lshr_b32 s53, s2, 3
    s_lshr_b32 s44, s52, 2
    s_mul_i32 s54, s44, 24
    s_add_u32 s18, s0, s54
    s_addc_u32 s19, s1, 0
    s_load_dwordx4 s[4:7], s[18:19], 0
    s_load_dwordx2 s[8:9], s[18:19], 16
    s_load_dwordx4 s[12:15], s[0:1], 48
    s_load_dwordx2 s[16:17], s[0:1], 64
    s_cmp_lt_u32 s53, 4
    s_cbranch_scc0 L_nocpf
    v_cmp_gt_u32 vcc, 64, v0
    s_nop 3
    s_and_saveexec_b64 s[68:69], vcc
    s_cbranch_execz L_cpfx
    s_getpc_b64 s[54:55]
L_pc:
    s_sub_u32 s54, s54, L_pc-concat_heads__linear_attn_block__sliding_local_dilated__prompt_kernel
    s_subb_u32 s55, s55, 0
    s_lshl_b32 s56, s53, 13
    v_lshlrev_b32 v148, 7, v0
    v_add_u32 v148, s56, v148
    v_min_u32 v148, L_end-concat_heads__linear_attn_block__sliding_local_dilated__prompt_kernel, v148
    global_load_dword v149, v148, s[54:55]
L_cpfx:
    s_mov_b64 exec, s[68:69]
L_nocpf:
    v_lshrrev_b32 v1, 6, v0
    v_and_b32 v0, 63, v0
    s_and_b32 s54, s52, 1
    s_lshl_b32 s54, s54, 3
    s_and_b32 s55, s53, 7
    s_add_u32 s45, s54, s55
    v_readfirstlane_b32 s47, v1
    s_lshr_b32 s54, s52, 1
    s_and_b32 s54, s54, 1
    s_lshl_b32 s54, s54, 2
    s_lshr_b32 s56, s53, 3
    s_add_u32 s46, s54, s56
    s_and_b32 s54, s52, 3
    s_lshl_b32 s54, s54, 3
    s_lshr_b32 s57, s53, 2
    s_add_u32 s48, s54, s57
    s_and_b32 s49, s53, 3
    s_lshl_b32 s51, s56, 1
    s_add_u32 s51, s51, s55
    s_and_b32 s51, s51, 7
    s_and_b32 s50, s47, 3
    s_cmp_lt_u32 s47, 4
    s_cbranch_scc1 L_compute
L_loader:
    s_setprio 3
    v_lshrrev_b32 v1, 3, v0
    v_and_b32 v2, 7, v0
    v_lshrrev_b32 v3, 1, v1
    v_or_b32 v4, 0, v3
    v_xor_b32 v4, v4, v2
    v_lshlrev_b32 v4, 4, v4
    v_lshl_add_u32 v4, v1, 11, v4
    v_add_u32 v8, 0, v4
    v_or_b32 v4, 4, v3
    v_xor_b32 v4, v4, v2
    v_lshlrev_b32 v4, 4, v4
    v_lshl_add_u32 v4, v1, 11, v4
    v_add_u32 v9, 16384, v4
    s_lshl_b32 s52, s50, 2
    v_add_u32 v4, s52, v1
    v_and_b32 v5, 7, v4
    v_lshlrev_b32 v5, 1, v5
    v_lshrrev_b32 v6, 3, v4
    v_add_u32 v5, v5, v6
    s_lshl_b32 s52, s45, 7
    s_sub_u32 s52, s52, 16
    v_add_u32 v5, s52, v5
    v_max_i32 v5, 0, v5
    v_lshrrev_b32 v6, 1, v4
    v_and_b32 v6, 7, v6
    v_xor_b32 v6, v6, v2
    v_lshlrev_b32 v6, 4, v6
    v_lshl_add_u32 v10, v5, 10, v6
    v_and_b32 v4, 1, v3
    v_lshrrev_b32 v5, 1, v2
    v_and_b32 v6, 1, v2
    v_mul_u32_u24 v7, 3072, v1
    v_or_b32 v16, 0, v4
    v_xor_b32 v16, v16, v5
    v_lshlrev_b32 v16, 5, v16
    v_lshl_add_u32 v16, v6, 4, v16
    v_add_u32 v16, v16, v7
    v_add_u32 v12, 0, v16
    v_or_b32 v16, 2, v4
    v_xor_b32 v16, v16, v5
    v_lshlrev_b32 v16, 5, v16
    v_lshl_add_u32 v16, v6, 4, v16
    v_add_u32 v16, v16, v7
    v_add_u32 v13, 24576, v16
    s_cmp_eq_u32 s44, 0
    s_cbranch_scc1 L_initA
    s_lshl_b32 s74, s50, 12
    s_lshl_b32 s75, s50, 9
    s_add_u32 s75, s75, 16384
    s_lshl_b32 s67, s50, 11
    s_add_u32 s67, s67, 18432
    s_lshl_b32 s52, s45, 17
    s_lshl_b32 s53, s50, 15
    s_add_u32 s18, s52, s53
    s_mul_i32 s52, s50, 49152
    s_lshl_b32 s53, s46, 7
    s_add_u32 s19, s52, s53
    s_waitcnt lgkmcnt(0)
    s_mov_b32 s20, s4
    s_and_b32 s21, s5, 0xffff
    s_mov_b32 s22, 0x200000
    s_mov_b32 s23, 0x00020000
    s_mov_b32 s24, s6
    s_and_b32 s25, s7, 0xffff
    s_mov_b32 s26, 0x180000
    s_mov_b32 s27, 0x00020000
    s_add_u32 s64, s51, 0
    s_and_b32 s64, s64, 7
    s_lshl_b32 s60, s64, 7
    s_add_u32 s58, s18, s60
    s_add_u32 s59, s58, 1024
    s_mul_i32 s61, s64, 196608
    s_add_u32 s61, s19, s61
    s_add_u32 s62, s61, 1024
    s_add_u32 s63, s61, 2048
    s_add_u32 m0, s67, 0
    s_nop 0
    buffer_load_dwordx4 v12, s[24:27], s61 offen lds
    s_add_u32 m0, s67, 1024
    s_nop 0
    buffer_load_dwordx4 v13, s[24:27], s61 offen lds
    s_add_u32 m0, s67, 8192
    s_nop 0
    buffer_load_dwordx4 v12, s[24:27], s62 offen lds
    s_add_u32 m0, s67, 9216
    s_nop 0
    buffer_load_dwordx4 v13, s[24:27], s62 offen lds
    s_add_u32 m0, s67, 16384
    s_nop 0
    buffer_load_dwordx4 v12, s[24:27], s63 offen lds
    s_add_u32 m0, s67, 17408
    s_nop 0
    buffer_load_dwordx4 v13, s[24:27], s63 offen lds
    s_add_u32 m0, s74, 0
    s_nop 0
    buffer_load_dwordx4 v8, s[20:23], s58 offen lds
    s_add_u32 m0, s74, 1024
    s_nop 0
    buffer_load_dwordx4 v9, s[20:23], s58 offen lds
    s_add_u32 m0, s74, 2048
    s_nop 0
    buffer_load_dwordx4 v8, s[20:23], s59 offen lds
    s_add_u32 m0, s74, 3072
    s_nop 0
    buffer_load_dwordx4 v9, s[20:23], s59 offen lds
    s_add_u32 m0, s75, 0
    s_mov_b32 exec_hi, 0
    buffer_load_dwordx4 v10, s[20:23], s60 offen lds
    s_mov_b32 exec_hi, -1
    s_add_u32 s64, s51, 1
    s_and_b32 s64, s64, 7
    s_lshl_b32 s60, s64, 7
    s_add_u32 s58, s18, s60
    s_add_u32 s59, s58, 1024
    s_mul_i32 s61, s64, 196608
    s_add_u32 s61, s19, s61
    s_add_u32 s62, s61, 1024
    s_add_u32 s63, s61, 2048
    s_add_u32 m0, s67, 43008
    s_nop 0
    buffer_load_dwordx4 v12, s[24:27], s61 offen lds
    s_add_u32 m0, s67, 44032
    s_nop 0
    buffer_load_dwordx4 v13, s[24:27], s61 offen lds
    s_add_u32 m0, s67, 51200
    s_nop 0
    buffer_load_dwordx4 v12, s[24:27], s62 offen lds
    s_add_u32 m0, s67, 52224
    s_nop 0
    buffer_load_dwordx4 v13, s[24:27], s62 offen lds
    s_add_u32 m0, s67, 59392
    s_nop 0
    buffer_load_dwordx4 v12, s[24:27], s63 offen lds
    s_add_u32 m0, s67, 60416
    s_nop 0
    buffer_load_dwordx4 v13, s[24:27], s63 offen lds
    s_add_u32 m0, s74, 43008
    s_nop 0
    buffer_load_dwordx4 v8, s[20:23], s58 offen lds
    s_add_u32 m0, s74, 44032
    s_nop 0
    buffer_load_dwordx4 v9, s[20:23], s58 offen lds
    s_add_u32 m0, s74, 45056
    s_nop 0
    buffer_load_dwordx4 v8, s[20:23], s59 offen lds
    s_add_u32 m0, s74, 46080
    s_nop 0
    buffer_load_dwordx4 v9, s[20:23], s59 offen lds
    s_add_u32 m0, s75, 43008
    s_mov_b32 exec_hi, 0
    buffer_load_dwordx4 v10, s[20:23], s60 offen lds
    s_mov_b32 exec_hi, -1
    s_branch L_rest1
L_initA:
    s_lshl_b32 s74, s50, 12
    s_lshl_b32 s75, s50, 9
    s_add_u32 s75, s75, 16384
    s_lshl_b32 s67, s50, 11
    s_add_u32 s67, s67, 114688
    s_lshl_b32 s52, s45, 17
    s_lshl_b32 s53, s50, 15
    s_add_u32 s18, s52, s53
    s_mul_i32 s52, s50, 49152
    s_lshl_b32 s53, s46, 7
    s_add_u32 s19, s52, s53
    s_waitcnt lgkmcnt(0)
    s_mov_b32 s20, s4
    s_and_b32 s21, s5, 0xffff
    s_mov_b32 s22, 0x200000
    s_mov_b32 s23, 0x00020000
    s_mov_b32 s24, s6
    s_and_b32 s25, s7, 0xffff
    s_mov_b32 s26, 0x180000
    s_mov_b32 s27, 0x00020000
    s_add_u32 s64, s51, 0
    s_and_b32 s64, s64, 7
    s_lshl_b32 s60, s64, 7
    s_mul_i32 s61, s64, 196608
    s_add_u32 s61, s19, s61
    s_add_u32 s62, s61, 1024
    s_add_u32 m0, s67, 0
    s_nop 0
    buffer_load_dwordx4 v12, s[24:27], s62 offen lds
    s_add_u32 m0, s67, 1024
    s_nop 0
    buffer_load_dwordx4 v13, s[24:27], s62 offen lds
    s_add_u32 s62, s61, 2048
    s_add_u32 m0, s67, 8192
    s_nop 0
    buffer_load_dwordx4 v12, s[24:27], s62 offen lds
    s_add_u32 m0, s67, 9216
    s_nop 0
    buffer_load_dwordx4 v13, s[24:27], s62 offen lds
    s_add_u32 s58, s18, s60
    s_add_u32 s59, s58, 1024
    s_add_u32 m0, s74, 0
    s_nop 0
    buffer_load_dwordx4 v8, s[20:23], s58 offen lds
    s_add_u32 m0, s74, 1024
    s_nop 0
    buffer_load_dwordx4 v9, s[20:23], s58 offen lds
    s_add_u32 m0, s74, 2048
    s_nop 0
    buffer_load_dwordx4 v8, s[20:23], s59 offen lds
    s_add_u32 m0, s74, 3072
    s_nop 0
    buffer_load_dwordx4 v9, s[20:23], s59 offen lds
    s_add_u32 s64, s51, 1
    s_and_b32 s64, s64, 7
    s_lshl_b32 s60, s64, 7
    s_mul_i32 s61, s64, 196608
    s_add_u32 s61, s19, s61
    s_add_u32 s62, s61, 1024
    s_add_u32 m0, s67, 16384
    s_nop 0
    buffer_load_dwordx4 v12, s[24:27], s62 offen lds
    s_add_u32 m0, s67, 17408
    s_nop 0
    buffer_load_dwordx4 v13, s[24:27], s62 offen lds
    s_add_u32 s62, s61, 2048
    s_add_u32 m0, s67, 24576
    s_nop 0
    buffer_load_dwordx4 v12, s[24:27], s62 offen lds
    s_add_u32 m0, s67, 25600
    s_nop 0
    buffer_load_dwordx4 v13, s[24:27], s62 offen lds
    s_add_u32 s58, s18, s60
    s_add_u32 s59, s58, 1024
    s_add_u32 m0, s74, 16384
    s_nop 0
    buffer_load_dwordx4 v8, s[20:23], s58 offen lds
    s_add_u32 m0, s74, 17408
    s_nop 0
    buffer_load_dwordx4 v9, s[20:23], s58 offen lds
    s_add_u32 m0, s74, 18432
    s_nop 0
    buffer_load_dwordx4 v8, s[20:23], s59 offen lds
    s_add_u32 m0, s74, 19456
    s_nop 0
    buffer_load_dwordx4 v9, s[20:23], s59 offen lds
    s_branch L_rest0
L_rest1:
    s_setprio 0
    s_mov_b32 s28, s8
    s_and_b32 s29, s9, 0xffff
    s_mov_b32 s30, 0x80000
    s_mov_b32 s31, 0x00020000
    s_mov_b32 s32, s12
    s_and_b32 s33, s13, 0xffff
    s_mov_b32 s34, 0x400000
    s_mov_b32 s35, 0x00020000
    s_mov_b32 s40, s14
    s_and_b32 s41, s15, 0xffff
    s_mov_b32 s42, 0x100
    s_mov_b32 s43, 0x00020000
    s_mov_b32 s36, s16
    s_and_b32 s37, s17, 0xffff
    s_mov_b32 s38, 0x10000000
    s_mov_b32 s39, 0x00020000
    v_lshrrev_b32 v3, 4, v0
    v_bfe_u32 v4, v0, 1, 3
    v_and_b32 v5, 1, v0
    s_lshl_b32 s52, s49, 8
    v_or_b32 v6, 0, v3
    v_xor_b32 v6, v6, v4
    v_lshlrev_b32 v6, 5, v6
    v_lshl_add_u32 v6, v5, 4, v6
    v_lshl_add_u32 v6, v3, 10, v6
    v_add_u32 v14, s52, v6
    v_or_b32 v6, 4, v3
    v_xor_b32 v6, v6, v4
    v_lshlrev_b32 v6, 5, v6
    v_lshl_add_u32 v6, v5, 4, v6
    v_lshl_add_u32 v6, v3, 10, v6
    v_add_u32 v15, s52, v6
    v_and_b32 v25, 7, v0
    v_lshlrev_b32 v25, 2, v25
    v_add_u32 v25, 128, v25
    v_mov_b32 v24, 0
    s_lshl_b32 s52, s45, 8
    s_lshl_b32 s53, s46, 2
    s_add_u32 s52, s52, s53
    s_add_u32 s52, s52, 4096
    v_mov_b32 v16, s52
    v_mov_b32 v17, 1
    s_waitcnt vmcnt(11)
    s_barrier
    s_add_u32 s64, s51, 2
    s_and_b32 s64, s64, 7
    s_lshl_b32 s60, s64, 7
    s_add_u32 s58, s18, s60
    s_add_u32 s59, s58, 1024
    s_mul_i32 s61, s64, 196608
    s_add_u32 s61, s19, s61
    s_add_u32 s62, s61, 1024
    s_add_u32 s63, s61, 2048
    s_add_u32 m0, s67, 86016
    s_nop 0
    buffer_load_dwordx4 v12, s[24:27], s61 offen lds
    s_add_u32 m0, s67, 87040
    s_nop 0
    buffer_load_dwordx4 v13, s[24:27], s61 offen lds
    s_add_u32 m0, s67, 94208
    s_nop 0
    buffer_load_dwordx4 v12, s[24:27], s62 offen lds
    s_add_u32 m0, s67, 95232
    s_nop 0
    buffer_load_dwordx4 v13, s[24:27], s62 offen lds
    s_add_u32 m0, s67, 102400
    s_nop 0
    buffer_load_dwordx4 v12, s[24:27], s63 offen lds
    s_add_u32 m0, s67, 103424
    s_nop 0
    buffer_load_dwordx4 v13, s[24:27], s63 offen lds
    s_add_u32 m0, s74, 86016
    s_nop 0
    buffer_load_dwordx4 v8, s[20:23], s58 offen lds
    s_add_u32 m0, s74, 87040
    s_nop 0
    buffer_load_dwordx4 v9, s[20:23], s58 offen lds
    s_add_u32 m0, s74, 88064
    s_nop 0
    buffer_load_dwordx4 v8, s[20:23], s59 offen lds
    s_add_u32 m0, s74, 89088
    s_nop 0
    buffer_load_dwordx4 v9, s[20:23], s59 offen lds
    s_add_u32 m0, s75, 86016
    s_mov_b32 exec_hi, 0
    buffer_load_dwordx4 v10, s[20:23], s60 offen lds
    s_mov_b32 exec_hi, -1
    s_waitcnt vmcnt(11)
    s_barrier
    s_add_u32 s64, s51, 3
    s_and_b32 s64, s64, 7
    s_lshl_b32 s60, s64, 7
    s_add_u32 s58, s18, s60
    s_add_u32 s59, s58, 1024
    s_mul_i32 s61, s64, 196608
    s_add_u32 s61, s19, s61
    s_add_u32 s62, s61, 1024
    s_add_u32 s63, s61, 2048
    s_add_u32 m0, s67, 0
    s_nop 0
    buffer_load_dwordx4 v12, s[24:27], s61 offen lds
    s_add_u32 m0, s67, 1024
    s_nop 0
    buffer_load_dwordx4 v13, s[24:27], s61 offen lds
    s_add_u32 m0, s67, 8192
    s_nop 0
    buffer_load_dwordx4 v12, s[24:27], s62 offen lds
    s_add_u32 m0, s67, 9216
    s_nop 0
    buffer_load_dwordx4 v13, s[24:27], s62 offen lds
    s_add_u32 m0, s67, 16384
    s_nop 0
    buffer_load_dwordx4 v12, s[24:27], s63 offen lds
    s_add_u32 m0, s67, 17408
    s_nop 0
    buffer_load_dwordx4 v13, s[24:27], s63 offen lds
    s_add_u32 m0, s74, 0
    s_nop 0
    buffer_load_dwordx4 v8, s[20:23], s58 offen lds
    s_add_u32 m0, s74, 1024
    s_nop 0
    buffer_load_dwordx4 v9, s[20:23], s58 offen lds
    s_add_u32 m0, s74, 2048
    s_nop 0
    buffer_load_dwordx4 v8, s[20:23], s59 offen lds
    s_add_u32 m0, s74, 3072
    s_nop 0
    buffer_load_dwordx4 v9, s[20:23], s59 offen lds
    s_add_u32 m0, s75, 0
    s_mov_b32 exec_hi, 0
    buffer_load_dwordx4 v10, s[20:23], s60 offen lds
    s_mov_b32 exec_hi, -1
    s_waitcnt vmcnt(11)
    s_barrier
    s_add_u32 s64, s51, 4
    s_and_b32 s64, s64, 7
    s_lshl_b32 s60, s64, 7
    s_add_u32 s58, s18, s60
    s_add_u32 s59, s58, 1024
    s_mul_i32 s61, s64, 196608
    s_add_u32 s61, s19, s61
    s_add_u32 s62, s61, 1024
    s_add_u32 s63, s61, 2048
    s_add_u32 m0, s67, 43008
    s_nop 0
    buffer_load_dwordx4 v12, s[24:27], s61 offen lds
    s_add_u32 m0, s67, 44032
    s_nop 0
    buffer_load_dwordx4 v13, s[24:27], s61 offen lds
    s_add_u32 m0, s67, 51200
    s_nop 0
    buffer_load_dwordx4 v12, s[24:27], s62 offen lds
    s_add_u32 m0, s67, 52224
    s_nop 0
    buffer_load_dwordx4 v13, s[24:27], s62 offen lds
    s_add_u32 m0, s67, 59392
    s_nop 0
    buffer_load_dwordx4 v12, s[24:27], s63 offen lds
    s_add_u32 m0, s67, 60416
    s_nop 0
    buffer_load_dwordx4 v13, s[24:27], s63 offen lds
    s_add_u32 m0, s74, 43008
    s_nop 0
    buffer_load_dwordx4 v8, s[20:23], s58 offen lds
    s_add_u32 m0, s74, 44032
    s_nop 0
    buffer_load_dwordx4 v9, s[20:23], s58 offen lds
    s_add_u32 m0, s74, 45056
    s_nop 0
    buffer_load_dwordx4 v8, s[20:23], s59 offen lds
    s_add_u32 m0, s74, 46080
    s_nop 0
    buffer_load_dwordx4 v9, s[20:23], s59 offen lds
    s_add_u32 m0, s75, 43008
    s_mov_b32 exec_hi, 0
    buffer_load_dwordx4 v10, s[20:23], s60 offen lds
    s_mov_b32 exec_hi, -1
    s_waitcnt vmcnt(11)
    s_barrier
    s_add_u32 s64, s51, 5
    s_and_b32 s64, s64, 7
    s_lshl_b32 s60, s64, 7
    s_add_u32 s58, s18, s60
    s_add_u32 s59, s58, 1024
    s_mul_i32 s61, s64, 196608
    s_add_u32 s61, s19, s61
    s_add_u32 s62, s61, 1024
    s_add_u32 s63, s61, 2048
    s_add_u32 m0, s67, 86016
    s_nop 0
    buffer_load_dwordx4 v12, s[24:27], s61 offen lds
    s_add_u32 m0, s67, 87040
    s_nop 0
    buffer_load_dwordx4 v13, s[24:27], s61 offen lds
    s_add_u32 m0, s67, 94208
    s_nop 0
    buffer_load_dwordx4 v12, s[24:27], s62 offen lds
    s_add_u32 m0, s67, 95232
    s_nop 0
    buffer_load_dwordx4 v13, s[24:27], s62 offen lds
    s_add_u32 m0, s67, 102400
    s_nop 0
    buffer_load_dwordx4 v12, s[24:27], s63 offen lds
    s_add_u32 m0, s67, 103424
    s_nop 0
    buffer_load_dwordx4 v13, s[24:27], s63 offen lds
    s_add_u32 m0, s74, 86016
    s_nop 0
    buffer_load_dwordx4 v8, s[20:23], s58 offen lds
    s_add_u32 m0, s74, 87040
    s_nop 0
    buffer_load_dwordx4 v9, s[20:23], s58 offen lds
    s_add_u32 m0, s74, 88064
    s_nop 0
    buffer_load_dwordx4 v8, s[20:23], s59 offen lds
    s_add_u32 m0, s74, 89088
    s_nop 0
    buffer_load_dwordx4 v9, s[20:23], s59 offen lds
    s_add_u32 m0, s75, 86016
    s_mov_b32 exec_hi, 0
    buffer_load_dwordx4 v10, s[20:23], s60 offen lds
    s_mov_b32 exec_hi, -1
    s_waitcnt vmcnt(11)
    s_barrier
    s_cmp_eq_u32 s50, 0
    s_cbranch_scc0 L_dbg_3
    buffer_load_dword v24, v25, s[40:43], 0 offen sc1
L_dbg_3:
    s_add_u32 s64, s51, 6
    s_and_b32 s64, s64, 7
    s_lshl_b32 s60, s64, 7
    s_add_u32 s58, s18, s60
    s_add_u32 s59, s58, 1024
    s_mul_i32 s61, s64, 196608
    s_add_u32 s61, s19, s61
    s_add_u32 s62, s61, 1024
    s_add_u32 s63, s61, 2048
    s_add_u32 m0, s67, 0
    s_nop 0
    buffer_load_dwordx4 v12, s[24:27], s61 offen lds
    s_add_u32 m0, s67, 1024
    s_nop 0
    buffer_load_dwordx4 v13, s[24:27], s61 offen lds
    s_add_u32 m0, s67, 8192
    s_nop 0
    buffer_load_dwordx4 v12, s[24:27], s62 offen lds
    s_add_u32 m0, s67, 9216
    s_nop 0
    buffer_load_dwordx4 v13, s[24:27], s62 offen lds
    s_add_u32 m0, s67, 16384
    s_nop 0
    buffer_load_dwordx4 v12, s[24:27], s63 offen lds
    s_add_u32 m0, s67, 17408
    s_nop 0
    buffer_load_dwordx4 v13, s[24:27], s63 offen lds
    s_add_u32 m0, s74, 0
    s_nop 0
    buffer_load_dwordx4 v8, s[20:23], s58 offen lds
    s_add_u32 m0, s74, 1024
    s_nop 0
    buffer_load_dwordx4 v9, s[20:23], s58 offen lds
    s_add_u32 m0, s74, 2048
    s_nop 0
    buffer_load_dwordx4 v8, s[20:23], s59 offen lds
    s_add_u32 m0, s74, 3072
    s_nop 0
    buffer_load_dwordx4 v9, s[20:23], s59 offen lds
    s_add_u32 m0, s75, 0
    s_mov_b32 exec_hi, 0
    buffer_load_dwordx4 v10, s[20:23], s60 offen lds
    s_mov_b32 exec_hi, -1
    s_waitcnt vmcnt(11)
    s_barrier
    s_add_u32 s64, s51, 7
    s_and_b32 s64, s64, 7
    s_lshl_b32 s60, s64, 7
    s_add_u32 s58, s18, s60
    s_add_u32 s59, s58, 1024
    s_mul_i32 s61, s64, 196608
    s_add_u32 s61, s19, s61
    s_add_u32 s62, s61, 1024
    s_add_u32 s63, s61, 2048
    s_add_u32 m0, s67, 43008
    s_nop 0
    buffer_load_dwordx4 v12, s[24:27], s61 offen lds
    s_add_u32 m0, s67, 44032
    s_nop 0
    buffer_load_dwordx4 v13, s[24:27], s61 offen lds
    s_add_u32 m0, s67, 51200
    s_nop 0
    buffer_load_dwordx4 v12, s[24:27], s62 offen lds
    s_add_u32 m0, s67, 52224
    s_nop 0
    buffer_load_dwordx4 v13, s[24:27], s62 offen lds
    s_add_u32 m0, s67, 59392
    s_nop 0
    buffer_load_dwordx4 v12, s[24:27], s63 offen lds
    s_add_u32 m0, s67, 60416
    s_nop 0
    buffer_load_dwordx4 v13, s[24:27], s63 offen lds
    s_add_u32 m0, s74, 43008
    s_nop 0
    buffer_load_dwordx4 v8, s[20:23], s58 offen lds
    s_add_u32 m0, s74, 44032
    s_nop 0
    buffer_load_dwordx4 v9, s[20:23], s58 offen lds
    s_add_u32 m0, s74, 45056
    s_nop 0
    buffer_load_dwordx4 v8, s[20:23], s59 offen lds
    s_add_u32 m0, s74, 46080
    s_nop 0
    buffer_load_dwordx4 v9, s[20:23], s59 offen lds
    s_add_u32 m0, s75, 43008
    s_mov_b32 exec_hi, 0
    buffer_load_dwordx4 v10, s[20:23], s60 offen lds
    s_mov_b32 exec_hi, -1
    s_lshl_b32 s52, s50, 12
    s_add_u32 s52, s52, 393216
    s_lshl_b32 s53, s50, 10
    s_add_u32 m0, s53, 131072
    s_nop 0
    buffer_load_dwordx4 v14, s[28:31], s52 offen lds
    s_lshl_b32 s52, s50, 12
    s_add_u32 s52, s52, 409600
    s_lshl_b32 s53, s50, 10
    s_add_u32 m0, s53, 135168
    s_nop 0
    buffer_load_dwordx4 v15, s[28:31], s52 offen lds
    s_lshl_b32 s52, s50, 12
    s_add_u32 s52, s52, 425984
    s_lshl_b32 s53, s50, 10
    s_add_u32 m0, s53, 139264
    s_nop 0
    buffer_load_dwordx4 v14, s[28:31], s52 offen lds
    s_lshl_b32 s52, s50, 12
    s_add_u32 s52, s52, 442368
    s_lshl_b32 s53, s50, 10
    s_add_u32 m0, s53, 143360
    s_nop 0
    buffer_load_dwordx4 v15, s[28:31], s52 offen lds
    s_lshl_b32 s52, s50, 12
    s_add_u32 s52, s52, 458752
    s_lshl_b32 s53, s50, 10
    s_add_u32 m0, s53, 147456
    s_nop 0
    buffer_load_dwordx4 v14, s[28:31], s52 offen lds
    s_lshl_b32 s52, s50, 12
    s_add_u32 s52, s52, 475136
    s_lshl_b32 s53, s50, 10
    s_add_u32 m0, s53, 151552
    s_nop 0
    buffer_load_dwordx4 v15, s[28:31], s52 offen lds
    s_lshl_b32 s52, s50, 12
    s_add_u32 s52, s52, 491520
    s_lshl_b32 s53, s50, 10
    s_add_u32 m0, s53, 155648
    s_nop 0
    buffer_load_dwordx4 v14, s[28:31], s52 offen lds
    s_lshl_b32 s52, s50, 12
    s_add_u32 s52, s52, 507904
    s_lshl_b32 s53, s50, 10
    s_add_u32 m0, s53, 159744
    s_nop 0
    buffer_load_dwordx4 v15, s[28:31], s52 offen lds
    s_waitcnt vmcnt(19)
    s_barrier
    s_lshl_b32 s52, s50, 12
    s_add_u32 s52, s52, 212992
    s_lshl_b32 s53, s50, 10
    s_add_u32 m0, s53, 86016
    s_nop 0
    buffer_load_dwordx4 v15, s[28:31], s52 offen lds
    s_lshl_b32 s52, s50, 12
    s_add_u32 s52, s52, 229376
    s_lshl_b32 s53, s50, 10
    s_add_u32 m0, s53, 90112
    s_nop 0
    buffer_load_dwordx4 v14, s[28:31], s52 offen lds
    s_lshl_b32 s52, s50, 12
    s_add_u32 s52, s52, 245760
    s_lshl_b32 s53, s50, 10
    s_add_u32 m0, s53, 94208
    s_nop 0
    buffer_load_dwordx4 v15, s[28:31], s52 offen lds
    s_lshl_b32 s52, s50, 12
    s_add_u32 s52, s52, 262144
    s_lshl_b32 s53, s50, 10
    s_add_u32 m0, s53, 98304
    s_nop 0
    buffer_load_dwordx4 v14, s[28:31], s52 offen lds
    s_lshl_b32 s52, s50, 12
    s_add_u32 s52, s52, 278528
    s_lshl_b32 s53, s50, 10
    s_add_u32 m0, s53, 102400
    s_nop 0
    buffer_load_dwordx4 v15, s[28:31], s52 offen lds
    s_lshl_b32 s52, s50, 12
    s_add_u32 s52, s52, 294912
    s_lshl_b32 s53, s50, 10
    s_add_u32 m0, s53, 106496
    s_nop 0
    buffer_load_dwordx4 v14, s[28:31], s52 offen lds
    s_lshl_b32 s52, s50, 12
    s_add_u32 s52, s52, 311296
    s_lshl_b32 s53, s50, 10
    s_add_u32 m0, s53, 110592
    s_nop 0
    buffer_load_dwordx4 v15, s[28:31], s52 offen lds
    s_lshl_b32 s52, s50, 12
    s_add_u32 s52, s52, 327680
    s_lshl_b32 s53, s50, 10
    s_add_u32 m0, s53, 114688
    s_nop 0
    buffer_load_dwordx4 v14, s[28:31], s52 offen lds
    s_lshl_b32 s52, s50, 12
    s_add_u32 s52, s52, 344064
    s_lshl_b32 s53, s50, 10
    s_add_u32 m0, s53, 118784
    s_nop 0
    buffer_load_dwordx4 v15, s[28:31], s52 offen lds
    s_lshl_b32 s52, s50, 12
    s_add_u32 s52, s52, 360448
    s_lshl_b32 s53, s50, 10
    s_add_u32 m0, s53, 122880
    s_nop 0
    buffer_load_dwordx4 v14, s[28:31], s52 offen lds
    s_lshl_b32 s52, s50, 12
    s_add_u32 s52, s52, 376832
    s_lshl_b32 s53, s50, 10
    s_add_u32 m0, s53, 126976
    s_nop 0
    buffer_load_dwordx4 v15, s[28:31], s52 offen lds
    s_waitcnt vmcnt(19)
    s_cmp_eq_u32 s50, 0
    s_cbranch_scc0 L_ini_4_x
    s_mov_b32 s66, 0
L_ini_4:
    v_cmp_eq_u32 vcc, 1, v24
    s_nop 3
    s_cmp_eq_u64 vcc, -1
    s_cbranch_scc1 L_ini_4_x
    s_add_u32 s66, s66, 1
    s_cmp_gt_u32 s66, 100000
    s_cbranch_scc1 L_ini_4_x
    buffer_load_dword v24, v25, s[40:43], 0 offen sc1
    s_waitcnt vmcnt(0)
    s_branch L_ini_4
L_ini_4_x:
    s_barrier
    s_lshl_b32 s52, s50, 12
    s_add_u32 s52, s52, 0
    s_lshl_b32 s53, s50, 10
    s_add_u32 m0, s53, 32768
    s_nop 0
    buffer_load_dwordx4 v14, s[28:31], s52 offen lds
    s_lshl_b32 s52, s50, 12
    s_add_u32 s52, s52, 16384
    s_lshl_b32 s53, s50, 10
    s_add_u32 m0, s53, 36864
    s_nop 0
    buffer_load_dwordx4 v15, s[28:31], s52 offen lds
    s_barrier
    s_lshl_b32 s52, s50, 12
    s_add_u32 s52, s52, 32768
    s_lshl_b32 s53, s50, 10
    s_add_u32 m0, s53, 40960
    s_nop 0
    buffer_load_dwordx4 v14, s[28:31], s52 offen lds
    s_lshl_b32 s52, s50, 12
    s_add_u32 s52, s52, 49152
    s_lshl_b32 s53, s50, 10
    s_add_u32 m0, s53, 45056
    s_nop 0
    buffer_load_dwordx4 v15, s[28:31], s52 offen lds
    s_lshl_b32 s52, s50, 12
    s_add_u32 s52, s52, 65536
    s_lshl_b32 s53, s50, 10
    s_add_u32 m0, s53, 49152
    s_nop 0
    buffer_load_dwordx4 v14, s[28:31], s52 offen lds
    s_lshl_b32 s52, s50, 12
    s_add_u32 s52, s52, 81920
    s_lshl_b32 s53, s50, 10
    s_add_u32 m0, s53, 53248
    s_nop 0
    buffer_load_dwordx4 v15, s[28:31], s52 offen lds
    s_lshl_b32 s52, s50, 12
    s_add_u32 s52, s52, 98304
    s_lshl_b32 s53, s50, 10
    s_add_u32 m0, s53, 57344
    s_nop 0
    buffer_load_dwordx4 v14, s[28:31], s52 offen lds
    s_lshl_b32 s52, s50, 12
    s_add_u32 s52, s52, 114688
    s_lshl_b32 s53, s50, 10
    s_add_u32 m0, s53, 61440
    s_nop 0
    buffer_load_dwordx4 v15, s[28:31], s52 offen lds
    s_lshl_b32 s52, s50, 12
    s_add_u32 s52, s52, 131072
    s_lshl_b32 s53, s50, 10
    s_add_u32 m0, s53, 65536
    s_nop 0
    buffer_load_dwordx4 v14, s[28:31], s52 offen lds
    s_lshl_b32 s52, s50, 12
    s_add_u32 s52, s52, 147456
    s_lshl_b32 s53, s50, 10
    s_add_u32 m0, s53, 69632
    s_nop 0
    buffer_load_dwordx4 v15, s[28:31], s52 offen lds
    s_lshl_b32 s52, s50, 12
    s_add_u32 s52, s52, 163840
    s_lshl_b32 s53, s50, 10
    s_add_u32 m0, s53, 73728
    s_nop 0
    buffer_load_dwordx4 v14, s[28:31], s52 offen lds
    s_lshl_b32 s52, s50, 12
    s_add_u32 s52, s52, 180224
    s_lshl_b32 s53, s50, 10
    s_add_u32 m0, s53, 77824
    s_nop 0
    buffer_load_dwordx4 v15, s[28:31], s52 offen lds
    s_lshl_b32 s52, s50, 12
    s_add_u32 s52, s52, 196608
    s_lshl_b32 s53, s50, 10
    s_add_u32 m0, s53, 81920
    s_nop 0
    buffer_load_dwordx4 v14, s[28:31], s52 offen lds
    s_waitcnt vmcnt(0)
    s_barrier
    s_cmp_eq_u32 s50, 0
    s_cbranch_scc0 L_nf_5
    s_mov_b64 s[68:69], exec
    s_mov_b64 exec, 1
    buffer_store_dword v17, v16, s[36:39], 0 offen sc1
    s_mov_b64 exec, s[68:69]
L_nf_5:
    s_branch L_p2wait
L_rest0:
    s_setprio 0
    s_mov_b32 s28, s8
    s_and_b32 s29, s9, 0xffff
    s_mov_b32 s30, 0x80000
    s_mov_b32 s31, 0x00020000
    s_mov_b32 s32, s12
    s_and_b32 s33, s13, 0xffff
    s_mov_b32 s34, 0x400000
    s_mov_b32 s35, 0x00020000
    s_mov_b32 s40, s14
    s_and_b32 s41, s15, 0xffff
    s_mov_b32 s42, 0x100
    s_mov_b32 s43, 0x00020000
    s_mov_b32 s36, s16
    s_and_b32 s37, s17, 0xffff
    s_mov_b32 s38, 0x10000000
    s_mov_b32 s39, 0x00020000
    v_lshrrev_b32 v3, 4, v0
    v_bfe_u32 v4, v0, 1, 3
    v_and_b32 v5, 1, v0
    s_lshl_b32 s52, s49, 8
    v_or_b32 v6, 0, v3
    v_xor_b32 v6, v6, v4
    v_lshlrev_b32 v6, 5, v6
    v_lshl_add_u32 v6, v5, 4, v6
    v_lshl_add_u32 v6, v3, 10, v6
    v_add_u32 v14, s52, v6
    v_or_b32 v6, 4, v3
    v_xor_b32 v6, v6, v4
    v_lshlrev_b32 v6, 5, v6
    v_lshl_add_u32 v6, v5, 4, v6
    v_lshl_add_u32 v6, v3, 10, v6
    v_add_u32 v15, s52, v6
    v_and_b32 v25, 7, v0
    v_lshlrev_b32 v25, 2, v25
    v_add_u32 v25, 128, v25
    v_mov_b32 v24, 0
    s_cmp_eq_u32 s45, 0
    s_cbranch_scc0 L_noinit
    s_lshl_b32 s52, s46, 2
    s_add_u32 s52, s52, s50
    s_lshl_b32 s53, s52, 10
    s_add_u32 s53, s53, 0x4000
    v_lshl_add_u32 v16, v0, 4, s53
    v_mov_b32 v20, 0
    v_mov_b32 v21, 0
    v_mov_b32 v22, 0
    v_mov_b32 v23, 0
    buffer_store_dwordx4 v[20:23], v16, s[36:39], 0 offen sc1
    s_lshl_b32 s53, s52, 6
    s_add_u32 s53, s53, 0xc000
    s_lshl_b32 s54, s52, 8
    s_add_u32 s54, s54, 0
    s_sub_u32 s54, s54, 64
    v_lshl_add_u32 v17, v0, 4, s53
    v_lshl_add_u32 v18, v0, 4, s54
    s_lshl_b32 s54, s46, 8
    s_add_u32 s54, s54, 7872
    v_lshl_add_u32 v19, v0, 4, s54
    v_cmp_gt_u32 vcc, 4, v0
    s_nop 1
    v_cndmask_b32 v17, v18, v17, vcc
    v_cmp_gt_u32 vcc, 20, v0
    s_nop 1
    v_cndmask_b32 v17, v19, v17, vcc
    s_mov_b64 s[68:69], exec
    s_mov_b64 exec, 0xffffff
    buffer_store_dwordx4 v[20:23], v17, s[36:39], 0 offen sc1
    s_mov_b64 exec, s[68:69]
L_noinit:
    s_lshl_b32 s52, s45, 8
    s_lshl_b32 s53, s46, 2
    s_add_u32 s52, s52, s53
    s_add_u32 s52, s52, 0
    v_mov_b32 v16, s52
    v_mov_b32 v17, 1
    s_lshl_b32 s52, s46, 8
    s_add_u32 s52, s52, 8192
    s_lshl_b32 s53, s45, 2
    s_add_u32 s53, s52, s53
    v_mov_b32 v18, s53
    v_and_b32 v19, 15, v0
    v_lshl_add_u32 v19, v19, 2, s52
    s_waitcnt vmcnt(8)
    s_barrier
    s_add_u32 s64, s51, 2
    s_and_b32 s64, s64, 7
    s_lshl_b32 s60, s64, 7
    s_mul_i32 s61, s64, 196608
    s_add_u32 s61, s19, s61
    s_add_u32 s62, s61, 1024
    s_add_u32 m0, s67, 32768
    s_nop 0
    buffer_load_dwordx4 v12, s[24:27], s62 offen lds
    s_add_u32 m0, s67, 33792
    s_nop 0
    buffer_load_dwordx4 v13, s[24:27], s62 offen lds
    s_add_u32 s62, s61, 2048
    s_add_u32 m0, s67, 40960
    s_nop 0
    buffer_load_dwordx4 v12, s[24:27], s62 offen lds
    s_add_u32 m0, s67, 41984
    s_nop 0
    buffer_load_dwordx4 v13, s[24:27], s62 offen lds
    s_add_u32 s58, s18, s60
    s_add_u32 s59, s58, 1024
    s_add_u32 m0, s74, 32768
    s_nop 0
    buffer_load_dwordx4 v8, s[20:23], s58 offen lds
    s_add_u32 m0, s74, 33792
    s_nop 0
    buffer_load_dwordx4 v9, s[20:23], s58 offen lds
    s_add_u32 m0, s74, 34816
    s_nop 0
    buffer_load_dwordx4 v8, s[20:23], s59 offen lds
    s_add_u32 m0, s74, 35840
    s_nop 0
    buffer_load_dwordx4 v9, s[20:23], s59 offen lds
    s_waitcnt vmcnt(8)
    s_barrier
    s_add_u32 s64, s51, 3
    s_and_b32 s64, s64, 7
    s_lshl_b32 s60, s64, 7
    s_mul_i32 s61, s64, 196608
    s_add_u32 s61, s19, s61
    s_add_u32 s62, s61, 1024
    s_add_u32 m0, s67, 0
    s_nop 0
    buffer_load_dwordx4 v12, s[24:27], s62 offen lds
    s_add_u32 m0, s67, 1024
    s_nop 0
    buffer_load_dwordx4 v13, s[24:27], s62 offen lds
    s_add_u32 s62, s61, 2048
    s_add_u32 m0, s67, 8192
    s_nop 0
    buffer_load_dwordx4 v12, s[24:27], s62 offen lds
    s_add_u32 m0, s67, 9216
    s_nop 0
    buffer_load_dwordx4 v13, s[24:27], s62 offen lds
    s_add_u32 s58, s18, s60
    s_add_u32 s59, s58, 1024
    s_add_u32 m0, s74, 49152
    s_nop 0
    buffer_load_dwordx4 v8, s[20:23], s58 offen lds
    s_add_u32 m0, s74, 50176
    s_nop 0
    buffer_load_dwordx4 v9, s[20:23], s58 offen lds
    s_add_u32 m0, s74, 51200
    s_nop 0
    buffer_load_dwordx4 v8, s[20:23], s59 offen lds
    s_add_u32 m0, s74, 52224
    s_nop 0
    buffer_load_dwordx4 v9, s[20:23], s59 offen lds
    s_waitcnt vmcnt(8)
    s_barrier
    s_cmp_eq_u32 s45, 0
    s_cbranch_scc0 L_ifl_6
    s_cmp_eq_u32 s50, 0
    s_cbranch_scc0 L_ifl_6
    s_lshl_b32 s52, s46, 2
    s_add_u32 s52, s52, 128
    v_mov_b32 v20, s52
    v_mov_b32 v21, 1
    s_mov_b64 s[68:69], exec
    s_mov_b64 exec, 1
    buffer_store_dword v21, v20, s[40:43], 0 offen sc1
    s_mov_b64 exec, s[68:69]
L_ifl_6:
    s_add_u32 s64, s51, 4
    s_and_b32 s64, s64, 7
    s_lshl_b32 s60, s64, 7
    s_mul_i32 s61, s64, 196608
    s_add_u32 s61, s19, s61
    s_add_u32 s62, s61, 1024
    s_add_u32 m0, s67, 16384
    s_nop 0
    buffer_load_dwordx4 v12, s[24:27], s62 offen lds
    s_add_u32 m0, s67, 17408
    s_nop 0
    buffer_load_dwordx4 v13, s[24:27], s62 offen lds
    s_add_u32 s62, s61, 2048
    s_add_u32 m0, s67, 24576
    s_nop 0
    buffer_load_dwordx4 v12, s[24:27], s62 offen lds
    s_add_u32 m0, s67, 25600
    s_nop 0
    buffer_load_dwordx4 v13, s[24:27], s62 offen lds
    s_add_u32 s58, s18, s60
    s_add_u32 s59, s58, 1024
    s_add_u32 m0, s74, 65536
    s_nop 0
    buffer_load_dwordx4 v8, s[20:23], s58 offen lds
    s_add_u32 m0, s74, 66560
    s_nop 0
    buffer_load_dwordx4 v9, s[20:23], s58 offen lds
    s_add_u32 m0, s74, 67584
    s_nop 0
    buffer_load_dwordx4 v8, s[20:23], s59 offen lds
    s_add_u32 m0, s74, 68608
    s_nop 0
    buffer_load_dwordx4 v9, s[20:23], s59 offen lds
    s_waitcnt vmcnt(8)
    s_barrier
    s_add_u32 s64, s51, 5
    s_and_b32 s64, s64, 7
    s_lshl_b32 s60, s64, 7
    s_mul_i32 s61, s64, 196608
    s_add_u32 s61, s19, s61
    s_add_u32 s62, s61, 1024
    s_add_u32 m0, s67, 32768
    s_nop 0
    buffer_load_dwordx4 v12, s[24:27], s62 offen lds
    s_add_u32 m0, s67, 33792
    s_nop 0
    buffer_load_dwordx4 v13, s[24:27], s62 offen lds
    s_add_u32 s62, s61, 2048
    s_add_u32 m0, s67, 40960
    s_nop 0
    buffer_load_dwordx4 v12, s[24:27], s62 offen lds
    s_add_u32 m0, s67, 41984
    s_nop 0
    buffer_load_dwordx4 v13, s[24:27], s62 offen lds
    s_add_u32 s58, s18, s60
    s_add_u32 s59, s58, 1024
    s_add_u32 m0, s74, 81920
    s_nop 0
    buffer_load_dwordx4 v8, s[20:23], s58 offen lds
    s_add_u32 m0, s74, 82944
    s_nop 0
    buffer_load_dwordx4 v9, s[20:23], s58 offen lds
    s_add_u32 m0, s74, 83968
    s_nop 0
    buffer_load_dwordx4 v8, s[20:23], s59 offen lds
    s_add_u32 m0, s74, 84992
    s_nop 0
    buffer_load_dwordx4 v9, s[20:23], s59 offen lds
    s_waitcnt vmcnt(8)
    s_barrier
    s_cmp_eq_u32 s50, 0
    s_cbranch_scc0 L_dbg_7
    buffer_load_dword v24, v25, s[40:43], 0 offen sc1
L_dbg_7:
    s_add_u32 s64, s51, 6
    s_and_b32 s64, s64, 7
    s_lshl_b32 s60, s64, 7
    s_mul_i32 s61, s64, 196608
    s_add_u32 s61, s19, s61
    s_add_u32 s62, s61, 1024
    s_add_u32 m0, s67, 0
    s_nop 0
    buffer_load_dwordx4 v12, s[24:27], s62 offen lds
    s_add_u32 m0, s67, 1024
    s_nop 0
    buffer_load_dwordx4 v13, s[24:27], s62 offen lds
    s_add_u32 s62, s61, 2048
    s_add_u32 m0, s67, 8192
    s_nop 0
    buffer_load_dwordx4 v12, s[24:27], s62 offen lds
    s_add_u32 m0, s67, 9216
    s_nop 0
    buffer_load_dwordx4 v13, s[24:27], s62 offen lds
    s_add_u32 s58, s18, s60
    s_add_u32 s59, s58, 1024
    s_add_u32 m0, s74, 98304
    s_nop 0
    buffer_load_dwordx4 v8, s[20:23], s58 offen lds
    s_add_u32 m0, s74, 99328
    s_nop 0
    buffer_load_dwordx4 v9, s[20:23], s58 offen lds
    s_add_u32 m0, s74, 100352
    s_nop 0
    buffer_load_dwordx4 v8, s[20:23], s59 offen lds
    s_add_u32 m0, s74, 101376
    s_nop 0
    buffer_load_dwordx4 v9, s[20:23], s59 offen lds
    s_waitcnt vmcnt(8)
    s_barrier
    s_add_u32 s64, s51, 7
    s_and_b32 s64, s64, 7
    s_lshl_b32 s60, s64, 7
    s_mul_i32 s61, s64, 196608
    s_add_u32 s61, s19, s61
    s_add_u32 s62, s61, 1024
    s_add_u32 m0, s67, 16384
    s_nop 0
    buffer_load_dwordx4 v12, s[24:27], s62 offen lds
    s_add_u32 m0, s67, 17408
    s_nop 0
    buffer_load_dwordx4 v13, s[24:27], s62 offen lds
    s_add_u32 s62, s61, 2048
    s_add_u32 m0, s67, 24576
    s_nop 0
    buffer_load_dwordx4 v12, s[24:27], s62 offen lds
    s_add_u32 m0, s67, 25600
    s_nop 0
    buffer_load_dwordx4 v13, s[24:27], s62 offen lds
    s_add_u32 s58, s18, s60
    s_add_u32 s59, s58, 1024
    s_add_u32 m0, s74, 0
    s_nop 0
    buffer_load_dwordx4 v8, s[20:23], s58 offen lds
    s_add_u32 m0, s74, 1024
    s_nop 0
    buffer_load_dwordx4 v9, s[20:23], s58 offen lds
    s_add_u32 m0, s74, 2048
    s_nop 0
    buffer_load_dwordx4 v8, s[20:23], s59 offen lds
    s_add_u32 m0, s74, 3072
    s_nop 0
    buffer_load_dwordx4 v9, s[20:23], s59 offen lds
    s_waitcnt vmcnt(8)
    s_barrier
    s_add_u32 s64, s51, 1
    s_and_b32 s64, s64, 7
    s_lshl_b32 s60, s64, 7
    s_mul_i32 s61, s64, 196608
    s_add_u32 s61, s19, s61
    s_add_u32 m0, s67, 32768
    s_nop 0
    buffer_load_dwordx4 v12, s[24:27], s61 offen lds
    s_add_u32 m0, s67, 33792
    s_nop 0
    buffer_load_dwordx4 v13, s[24:27], s61 offen lds
    s_add_u32 s64, s51, 2
    s_and_b32 s64, s64, 7
    s_lshl_b32 s60, s64, 7
    s_mul_i32 s61, s64, 196608
    s_add_u32 s61, s19, s61
    s_add_u32 m0, s67, 40960
    s_nop 0
    buffer_load_dwordx4 v12, s[24:27], s61 offen lds
    s_add_u32 m0, s67, 41984
    s_nop 0
    buffer_load_dwordx4 v13, s[24:27], s61 offen lds
    s_waitcnt vmcnt(4)
    s_cmp_eq_u32 s50, 0
    s_cbranch_scc0 L_ini_8_x
    s_mov_b32 s66, 0
L_ini_8:
    v_cmp_eq_u32 vcc, 1, v24
    s_nop 3
    s_cmp_eq_u64 vcc, -1
    s_cbranch_scc1 L_ini_8_x
    s_add_u32 s66, s66, 1
    s_cmp_gt_u32 s66, 100000
    s_cbranch_scc1 L_ini_8_x
    buffer_load_dword v24, v25, s[40:43], 0 offen sc1
    s_waitcnt vmcnt(0)
    s_branch L_ini_8
L_ini_8_x:
    s_barrier
    s_add_u32 s64, s51, 3
    s_and_b32 s64, s64, 7
    s_lshl_b32 s60, s64, 7
    s_mul_i32 s61, s64, 196608
    s_add_u32 s61, s19, s61
    s_add_u32 m0, s67, 0
    s_nop 0
    buffer_load_dwordx4 v12, s[24:27], s61 offen lds
    s_add_u32 m0, s67, 1024
    s_nop 0
    buffer_load_dwordx4 v13, s[24:27], s61 offen lds
    s_add_u32 s64, s51, 4
    s_and_b32 s64, s64, 7
    s_lshl_b32 s60, s64, 7
    s_mul_i32 s61, s64, 196608
    s_add_u32 s61, s19, s61
    s_add_u32 m0, s67, 8192
    s_nop 0
    buffer_load_dwordx4 v12, s[24:27], s61 offen lds
    s_add_u32 m0, s67, 9216
    s_nop 0
    buffer_load_dwordx4 v13, s[24:27], s61 offen lds
    s_waitcnt vmcnt(4)
    s_barrier
    s_add_u32 s64, s51, 5
    s_and_b32 s64, s64, 7
    s_lshl_b32 s60, s64, 7
    s_mul_i32 s61, s64, 196608
    s_add_u32 s61, s19, s61
    s_add_u32 m0, s67, 16384
    s_nop 0
    buffer_load_dwordx4 v12, s[24:27], s61 offen lds
    s_add_u32 m0, s67, 17408
    s_nop 0
    buffer_load_dwordx4 v13, s[24:27], s61 offen lds
    s_add_u32 s64, s51, 6
    s_and_b32 s64, s64, 7
    s_lshl_b32 s60, s64, 7
    s_mul_i32 s61, s64, 196608
    s_add_u32 s61, s19, s61
    s_add_u32 m0, s67, 24576
    s_nop 0
    buffer_load_dwordx4 v12, s[24:27], s61 offen lds
    s_add_u32 m0, s67, 25600
    s_nop 0
    buffer_load_dwordx4 v13, s[24:27], s61 offen lds
    s_waitcnt vmcnt(4)
    s_barrier
    s_add_u32 s64, s51, 7
    s_and_b32 s64, s64, 7
    s_lshl_b32 s60, s64, 7
    s_mul_i32 s61, s64, 196608
    s_add_u32 s61, s19, s61
    s_add_u32 m0, s67, 32768
    s_nop 0
    buffer_load_dwordx4 v12, s[24:27], s61 offen lds
    s_add_u32 m0, s67, 33792
    s_nop 0
    buffer_load_dwordx4 v13, s[24:27], s61 offen lds
    s_add_u32 s64, s51, 0
    s_and_b32 s64, s64, 7
    s_lshl_b32 s60, s64, 7
    s_mul_i32 s61, s64, 196608
    s_add_u32 s61, s19, s61
    s_add_u32 m0, s67, 40960
    s_nop 0
    buffer_load_dwordx4 v12, s[24:27], s61 offen lds
    s_add_u32 m0, s67, 41984
    s_nop 0
    buffer_load_dwordx4 v13, s[24:27], s61 offen lds
    s_add_u32 s64, s51, 0
    s_and_b32 s64, s64, 7
    s_lshl_b32 s60, s64, 7
    s_add_u32 s58, s18, s60
    s_add_u32 s59, s58, 1024
    s_add_u32 m0, s74, 16384
    s_nop 0
    buffer_load_dwordx4 v8, s[20:23], s58 offen lds
    s_add_u32 m0, s74, 17408
    s_nop 0
    buffer_load_dwordx4 v9, s[20:23], s58 offen lds
    s_add_u32 m0, s74, 18432
    s_nop 0
    buffer_load_dwordx4 v8, s[20:23], s59 offen lds
    s_add_u32 m0, s74, 19456
    s_nop 0
    buffer_load_dwordx4 v9, s[20:23], s59 offen lds
    s_lshl_b32 s52, s50, 12
    s_add_u32 s52, s52, 0
    s_lshl_b32 s53, s50, 10
    s_add_u32 m0, s53, 32768
    s_nop 0
    buffer_load_dwordx4 v14, s[28:31], s52 offen lds
    s_lshl_b32 s52, s50, 12
    s_add_u32 s52, s52, 16384
    s_lshl_b32 s53, s50, 10
    s_add_u32 m0, s53, 36864
    s_nop 0
    buffer_load_dwordx4 v15, s[28:31], s52 offen lds
    s_lshl_b32 s52, s50, 12
    s_add_u32 s52, s52, 32768
    s_lshl_b32 s53, s50, 10
    s_add_u32 m0, s53, 40960
    s_nop 0
    buffer_load_dwordx4 v14, s[28:31], s52 offen lds
    s_lshl_b32 s52, s50, 12
    s_add_u32 s52, s52, 49152
    s_lshl_b32 s53, s50, 10
    s_add_u32 m0, s53, 45056
    s_nop 0
    buffer_load_dwordx4 v15, s[28:31], s52 offen lds
    s_waitcnt vmcnt(12)
    s_barrier
    s_cmp_eq_u32 s50, 0
    s_cbranch_scc0 L_nf_9
    s_mov_b64 s[68:69], exec
    s_mov_b64 exec, 1
    buffer_store_dword v17, v18, s[36:39], 0 offen sc1
    s_mov_b64 exec, s[68:69]
L_nf_9:
    s_lshl_b32 s52, s50, 12
    s_add_u32 s52, s52, 65536
    s_lshl_b32 s53, s50, 10
    s_add_u32 m0, s53, 49152
    s_nop 0
    buffer_load_dwordx4 v14, s[28:31], s52 offen lds
    s_lshl_b32 s52, s50, 12
    s_add_u32 s52, s52, 81920
    s_lshl_b32 s53, s50, 10
    s_add_u32 m0, s53, 53248
    s_nop 0
    buffer_load_dwordx4 v15, s[28:31], s52 offen lds
    s_lshl_b32 s52, s50, 12
    s_add_u32 s52, s52, 98304
    s_lshl_b32 s53, s50, 10
    s_add_u32 m0, s53, 57344
    s_nop 0
    buffer_load_dwordx4 v14, s[28:31], s52 offen lds
    s_lshl_b32 s52, s50, 12
    s_add_u32 s52, s52, 114688
    s_lshl_b32 s53, s50, 10
    s_add_u32 m0, s53, 61440
    s_nop 0
    buffer_load_dwordx4 v15, s[28:31], s52 offen lds
    s_lshl_b32 s52, s50, 12
    s_add_u32 s52, s52, 131072
    s_lshl_b32 s53, s50, 10
    s_add_u32 m0, s53, 65536
    s_nop 0
    buffer_load_dwordx4 v14, s[28:31], s52 offen lds
    s_lshl_b32 s52, s50, 12
    s_add_u32 s52, s52, 147456
    s_lshl_b32 s53, s50, 10
    s_add_u32 m0, s53, 69632
    s_nop 0
    buffer_load_dwordx4 v15, s[28:31], s52 offen lds
    s_lshl_b32 s52, s50, 12
    s_add_u32 s52, s52, 163840
    s_lshl_b32 s53, s50, 10
    s_add_u32 m0, s53, 73728
    s_nop 0
    buffer_load_dwordx4 v14, s[28:31], s52 offen lds
    s_lshl_b32 s52, s50, 12
    s_add_u32 s52, s52, 180224
    s_lshl_b32 s53, s50, 10
    s_add_u32 m0, s53, 77824
    s_nop 0
    buffer_load_dwordx4 v15, s[28:31], s52 offen lds
    s_waitcnt vmcnt(12)
    s_barrier
    s_lshl_b32 s52, s50, 12
    s_add_u32 s52, s52, 327680
    s_lshl_b32 s53, s50, 10
    s_add_u32 m0, s53, 114688
    s_nop 0
    buffer_load_dwordx4 v14, s[28:31], s52 offen lds
    s_lshl_b32 s52, s50, 12
    s_add_u32 s52, s52, 344064
    s_lshl_b32 s53, s50, 10
    s_add_u32 m0, s53, 118784
    s_nop 0
    buffer_load_dwordx4 v15, s[28:31], s52 offen lds
    s_lshl_b32 s52, s50, 12
    s_add_u32 s52, s52, 360448
    s_lshl_b32 s53, s50, 10
    s_add_u32 m0, s53, 122880
    s_nop 0
    buffer_load_dwordx4 v14, s[28:31], s52 offen lds
    s_lshl_b32 s52, s50, 12
    s_add_u32 s52, s52, 376832
    s_lshl_b32 s53, s50, 10
    s_add_u32 m0, s53, 126976
    s_nop 0
    buffer_load_dwordx4 v15, s[28:31], s52 offen lds
    s_cmp_eq_u32 s50, 0
    s_cbranch_scc0 L_kp_10_n
    buffer_load_dword v20, v19, s[36:39], 0 offen sc1
L_kp_10_n:
    s_lshl_b32 s52, s46, 12
    s_add_u32 s52, s52, 0x4000
    v_lshl_add_u32 v22, v0, 4, s52
    s_lshl_b32 s52, s46, 8
    s_add_u32 s52, s52, 0xc000
    v_lshl_add_u32 v23, v0, 4, s52
    s_barrier
    s_cmp_eq_u32 s50, 0
    s_cbranch_scc1 L_kp_10_p
    s_lshl_b32 s52, s50, 12
    s_add_u32 s52, s52, 196608
    s_lshl_b32 s53, s50, 10
    s_add_u32 m0, s53, 81920
    s_nop 0
    buffer_load_dwordx4 v14, s[28:31], s52 offen lds
    s_lshl_b32 s52, s50, 12
    s_add_u32 s52, s52, 212992
    s_lshl_b32 s53, s50, 10
    s_add_u32 m0, s53, 86016
    s_nop 0
    buffer_load_dwordx4 v15, s[28:31], s52 offen lds
    s_lshl_b32 s52, s50, 12
    s_add_u32 s52, s52, 229376
    s_lshl_b32 s53, s50, 10
    s_add_u32 m0, s53, 90112
    s_nop 0
    buffer_load_dwordx4 v14, s[28:31], s52 offen lds
    s_lshl_b32 s52, s50, 12
    s_add_u32 s52, s52, 245760
    s_lshl_b32 s53, s50, 10
    s_add_u32 m0, s53, 94208
    s_nop 0
    buffer_load_dwordx4 v15, s[28:31], s52 offen lds
    s_lshl_b32 s52, s50, 12
    s_add_u32 s52, s52, 262144
    s_lshl_b32 s53, s50, 10
    s_add_u32 m0, s53, 98304
    s_nop 0
    buffer_load_dwordx4 v14, s[28:31], s52 offen lds
    s_lshl_b32 s52, s50, 12
    s_add_u32 s52, s52, 278528
    s_lshl_b32 s53, s50, 10
    s_add_u32 m0, s53, 102400
    s_nop 0
    buffer_load_dwordx4 v15, s[28:31], s52 offen lds
    s_lshl_b32 s52, s50, 12
    s_add_u32 s52, s52, 294912
    s_lshl_b32 s53, s50, 10
    s_add_u32 m0, s53, 106496
    s_nop 0
    buffer_load_dwordx4 v14, s[28:31], s52 offen lds
    s_lshl_b32 s52, s50, 12
    s_add_u32 s52, s52, 311296
    s_lshl_b32 s53, s50, 10
    s_add_u32 m0, s53, 110592
    s_nop 0
    buffer_load_dwordx4 v15, s[28:31], s52 offen lds
    s_lshl_b32 s52, s50, 12
    s_add_u32 s52, s52, 393216
    s_lshl_b32 s53, s50, 10
    s_add_u32 m0, s53, 131072
    s_nop 0
    buffer_load_dwordx4 v14, s[28:31], s52 offen lds
    s_lshl_b32 s52, s50, 12
    s_add_u32 s52, s52, 409600
    s_lshl_b32 s53, s50, 10
    s_add_u32 m0, s53, 135168
    s_nop 0
    buffer_load_dwordx4 v15, s[28:31], s52 offen lds
    s_lshl_b32 s52, s50, 12
    s_add_u32 s52, s52, 425984
    s_lshl_b32 s53, s50, 10
    s_add_u32 m0, s53, 139264
    s_nop 0
    buffer_load_dwordx4 v14, s[28:31], s52 offen lds
    s_lshl_b32 s52, s50, 12
    s_add_u32 s52, s52, 442368
    s_lshl_b32 s53, s50, 10
    s_add_u32 m0, s53, 143360
    s_nop 0
    buffer_load_dwordx4 v15, s[28:31], s52 offen lds
    s_lshl_b32 s52, s50, 12
    s_add_u32 s52, s52, 458752
    s_lshl_b32 s53, s50, 10
    s_add_u32 m0, s53, 147456
    s_nop 0
    buffer_load_dwordx4 v14, s[28:31], s52 offen lds
    s_lshl_b32 s52, s50, 12
    s_add_u32 s52, s52, 475136
    s_lshl_b32 s53, s50, 10
    s_add_u32 m0, s53, 151552
    s_nop 0
    buffer_load_dwordx4 v15, s[28:31], s52 offen lds
    s_lshl_b32 s52, s50, 12
    s_add_u32 s52, s52, 491520
    s_lshl_b32 s53, s50, 10
    s_add_u32 m0, s53, 155648
    s_nop 0
    buffer_load_dwordx4 v14, s[28:31], s52 offen lds
    s_lshl_b32 s52, s50, 12
    s_add_u32 s52, s52, 507904
    s_lshl_b32 s53, s50, 10
    s_add_u32 m0, s53, 159744
    s_nop 0
    buffer_load_dwordx4 v15, s[28:31], s52 offen lds
    s_branch L_kp_10_y
L_kp_10_p:
    s_mov_b32 s66, 0
    s_waitcnt vmcnt(0)
    v_cmp_eq_u32 vcc, 1, v20
    s_nop 3
    s_cmp_eq_u64 vcc, -1
    s_cbranch_scc1 L_kp_10_x
    s_waitcnt vmcnt(0)
L_kp_10:
    buffer_load_dword v20, v19, s[36:39], 0 offen sc1
    s_waitcnt vmcnt(0)
    v_cmp_eq_u32 vcc, 1, v20
    s_nop 3
    s_cmp_eq_u64 vcc, -1
    s_cbranch_scc1 L_kp_10_x
    s_add_u32 s66, s66, 1
    s_cmp_gt_u32 s66, 100000
    s_cbranch_scc1 L_kp_10_x
    s_sleep 4
    s_branch L_kp_10
L_kp_10_x:
    s_mov_b32 m0, 0
    s_mov_b32 s52, 0
    buffer_load_dwordx4 v22, s[36:39], s52 offen sc1 lds
    s_mov_b32 m0, 1024
    s_mov_b32 s52, 1024
    buffer_load_dwordx4 v22, s[36:39], s52 offen sc1 lds
    s_mov_b32 m0, 2048
    s_mov_b32 s52, 2048
    buffer_load_dwordx4 v22, s[36:39], s52 offen sc1 lds
    s_mov_b32 m0, 3072
    s_mov_b32 s52, 3072
    buffer_load_dwordx4 v22, s[36:39], s52 offen sc1 lds
    s_mov_b32 m0, 4096
    s_mov_b64 exec, 0xffff
    buffer_load_dwordx4 v23, s[36:39], 0 offen sc1 lds
    s_mov_b64 exec, -1
    s_lshl_b32 s52, s50, 12
    s_add_u32 s52, s52, 196608
    s_lshl_b32 s53, s50, 10
    s_add_u32 m0, s53, 81920
    s_nop 0
    buffer_load_dwordx4 v14, s[28:31], s52 offen lds
    s_lshl_b32 s52, s50, 12
    s_add_u32 s52, s52, 212992
    s_lshl_b32 s53, s50, 10
    s_add_u32 m0, s53, 86016
    s_nop 0
    buffer_load_dwordx4 v15, s[28:31], s52 offen lds
    s_lshl_b32 s52, s50, 12
    s_add_u32 s52, s52, 229376
    s_lshl_b32 s53, s50, 10
    s_add_u32 m0, s53, 90112
    s_nop 0
    buffer_load_dwordx4 v14, s[28:31], s52 offen lds
    s_lshl_b32 s52, s50, 12
    s_add_u32 s52, s52, 245760
    s_lshl_b32 s53, s50, 10
    s_add_u32 m0, s53, 94208
    s_nop 0
    buffer_load_dwordx4 v15, s[28:31], s52 offen lds
    s_lshl_b32 s52, s50, 12
    s_add_u32 s52, s52, 262144
    s_lshl_b32 s53, s50, 10
    s_add_u32 m0, s53, 98304
    s_nop 0
    buffer_load_dwordx4 v14, s[28:31], s52 offen lds
    s_lshl_b32 s52, s50, 12
    s_add_u32 s52, s52, 278528
    s_lshl_b32 s53, s50, 10
    s_add_u32 m0, s53, 102400
    s_nop 0
    buffer_load_dwordx4 v15, s[28:31], s52 offen lds
    s_lshl_b32 s52, s50, 12
    s_add_u32 s52, s52, 294912
    s_lshl_b32 s53, s50, 10
    s_add_u32 m0, s53, 106496
    s_nop 0
    buffer_load_dwordx4 v14, s[28:31], s52 offen lds
    s_lshl_b32 s52, s50, 12
    s_add_u32 s52, s52, 311296
    s_lshl_b32 s53, s50, 10
    s_add_u32 m0, s53, 110592
    s_nop 0
    buffer_load_dwordx4 v15, s[28:31], s52 offen lds
    s_lshl_b32 s52, s50, 12
    s_add_u32 s52, s52, 393216
    s_lshl_b32 s53, s50, 10
    s_add_u32 m0, s53, 131072
    s_nop 0
    buffer_load_dwordx4 v14, s[28:31], s52 offen lds
    s_lshl_b32 s52, s50, 12
    s_add_u32 s52, s52, 409600
    s_lshl_b32 s53, s50, 10
    s_add_u32 m0, s53, 135168
    s_nop 0
    buffer_load_dwordx4 v15, s[28:31], s52 offen lds
    s_lshl_b32 s52, s50, 12
    s_add_u32 s52, s52, 425984
    s_lshl_b32 s53, s50, 10
    s_add_u32 m0, s53, 139264
    s_nop 0
    buffer_load_dwordx4 v14, s[28:31], s52 offen lds
    s_lshl_b32 s52, s50, 12
    s_add_u32 s52, s52, 442368
    s_lshl_b32 s53, s50, 10
    s_add_u32 m0, s53, 143360
    s_nop 0
    buffer_load_dwordx4 v15, s[28:31], s52 offen lds
    s_lshl_b32 s52, s50, 12
    s_add_u32 s52, s52, 458752
    s_lshl_b32 s53, s50, 10
    s_add_u32 m0, s53, 147456
    s_nop 0
    buffer_load_dwordx4 v14, s[28:31], s52 offen lds
    s_lshl_b32 s52, s50, 12
    s_add_u32 s52, s52, 475136
    s_lshl_b32 s53, s50, 10
    s_add_u32 m0, s53, 151552
    s_nop 0
    buffer_load_dwordx4 v15, s[28:31], s52 offen lds
    s_lshl_b32 s52, s50, 12
    s_add_u32 s52, s52, 491520
    s_lshl_b32 s53, s50, 10
    s_add_u32 m0, s53, 155648
    s_nop 0
    buffer_load_dwordx4 v14, s[28:31], s52 offen lds
    s_lshl_b32 s52, s50, 12
    s_add_u32 s52, s52, 507904
    s_lshl_b32 s53, s50, 10
    s_add_u32 m0, s53, 159744
    s_nop 0
    buffer_load_dwordx4 v15, s[28:31], s52 offen lds
    s_waitcnt vmcnt(16)
L_kp_10_y:
    s_barrier
    s_waitcnt vmcnt(0)
    s_barrier
    s_cmp_eq_u32 s50, 0
    s_cbranch_scc0 L_nf_11
    s_mov_b64 s[68:69], exec
    s_mov_b64 exec, 1
    buffer_store_dword v17, v16, s[36:39], 0 offen sc1
    s_mov_b64 exec, s[68:69]
L_nf_11:
    s_branch L_p2wait
L_compute:
    s_waitcnt lgkmcnt(0)
    s_mov_b32 s20, s4
    s_and_b32 s21, s5, 0xffff
    s_mov_b32 s22, 0x200000
    s_mov_b32 s23, 0x00020000
    s_mov_b32 s24, s6
    s_and_b32 s25, s7, 0xffff
    s_mov_b32 s26, 0x180000
    s_mov_b32 s27, 0x00020000
    s_mov_b32 s28, s8
    s_and_b32 s29, s9, 0xffff
    s_mov_b32 s30, 0x80000
    s_mov_b32 s31, 0x00020000
    s_mov_b32 s32, s12
    s_and_b32 s33, s13, 0xffff
    s_mov_b32 s34, 0x400000
    s_mov_b32 s35, 0x00020000
    s_mov_b32 s40, s14
    s_and_b32 s41, s15, 0xffff
    s_mov_b32 s42, 0x100
    s_mov_b32 s43, 0x00020000
    s_mov_b32 s36, s16
    s_and_b32 s37, s17, 0xffff
    s_mov_b32 s38, 0x10000000
    s_mov_b32 s39, 0x00020000
    v_and_b32 v1, 15, v0
    v_lshrrev_b32 v2, 4, v0
    v_lshrrev_b32 v3, 1, v1
    v_xor_b32 v4, v3, v2
    v_lshlrev_b32 v5, 7, v1
    v_lshl_add_u32 v5, v4, 4, v5
    v_add_u32 v112, 0, v5
    v_xor_b32 v113, 64, v112
    v_add_u32 v114, 43008, v5
    v_xor_b32 v115, 64, v114
    v_add_u32 v116, 86016, v5
    v_xor_b32 v117, 64, v116
    v_bfe_u32 v3, v0, 2, 2
    v_and_b32 v4, 3, v0
    v_lshl_add_u32 v5, v2, 3, v3
    v_lshlrev_b32 v5, 7, v5
    v_lshrrev_b32 v6, 1, v3
    v_and_b32 v7, 1, v2
    v_lshl_or_b32 v6, v7, 1, v6
    v_xor_b32 v6, s47, v6
    v_lshl_add_u32 v5, v6, 5, v5
    v_lshl_add_u32 v5, v4, 3, v5
    v_add_u32 v118, 18432, v5
    v_add_u32 v119, 61440, v5
    v_add_u32 v120, 104448, v5
    s_cmp_eq_u32 s44, 0
    s_cbranch_scc0 L_mainB
L_mainA:
    v_mov_b32 v140, 0x358637bd
    v_mov_b32 v141, v140
    v_mov_b32 v142, v140
    v_mov_b32 v143, v140
    v_and_b32 v3, 1, v2
    v_lshlrev_b32 v3, 14, v3
    v_lshrrev_b32 v4, 1, v2
    v_lshl_add_u32 v3, v4, 9, v3
    v_lshl_add_u32 v3, v1, 4, v3
    s_lshl_b32 s52, s45, 17
    s_lshl_b32 s53, s46, 11
    s_add_u32 s52, s52, s53
    s_lshr_b32 s53, s47, 1
    s_lshl_b32 s53, s53, 10
    s_add_u32 s52, s52, s53
    s_and_b32 s53, s47, 1
    s_lshl_b32 s53, s53, 8
    s_add_u32 s52, s52, s53
    s_lshl_b32 s53, s44, 21
    s_add_u32 s52, s52, s53
    s_add_u32 s52, s52, 0x100000
    v_add_u32 v7, s52, v3
    s_lshl_b32 s52, s46, 2
    s_add_u32 s52, s52, s47
    s_lshl_b32 s53, s52, 10
    s_add_u32 s53, s53, 0x4000
    v_lshl_add_u32 v6, v0, 2, s53
    s_lshl_b32 s53, s52, 6
    s_add_u32 s53, s53, 0xc000
    v_lshl_add_u32 v5, v0, 2, s53
    s_mov_b32 s70, 0x3fb8aa3b
    s_mov_b32 s71, 0x3fb8aa3b
    s_mov_b32 s72, 0x358637bd
    s_mov_b32 s73, 0xb5c1a2a0
    v_mov_b32 v2, s73
    v_mov_b32 v3, s73
    v_mov_b32 v72, 0x3f803f80
    v_mov_b32 v73, 0x3f803f80
    v_mov_b32 v74, 0x3f803f80
    v_mov_b32 v75, 0x3f803f80
    v_add_u32 v114, 0x10000, v112
    v_add_u32 v115, 0x10000, v113
    v_add_u32 v118, 96256, v118
    s_barrier
    ds_read_b64_tr_b16 a[36:37], v118 offset:0
    ds_read_b64_tr_b16 a[38:39], v118 offset:512
    ds_read_b64_tr_b16 a[40:41], v118 offset:8192
    ds_read_b64_tr_b16 a[42:43], v118 offset:8704
    ds_read_b128 a[0:3], v112 offset:0
    ds_read_b128 a[4:7], v112 offset:2048
    ds_read_b128 a[8:11], v112 offset:4096
    ds_read_b128 a[12:15], v112 offset:6144
    ds_read_b128 a[16:19], v112 offset:8192
    ds_read_b128 a[20:23], v112 offset:10240
    ds_read_b128 a[24:27], v112 offset:12288
    ds_read_b128 a[28:31], v112 offset:14336
    s_waitcnt lgkmcnt(7)
    v_mfma_f32_16x16x32_bf16 v[40:43], a[0:3], a[36:39], v[140:143]
    ds_read_b64_tr_b16 a[48:49], v118 offset:4096
    v_mfma_f32_16x16x32_bf16 v[76:79], a[0:3], a[40:43], 0
    ds_read_b128 a[0:3], v113 offset:0
    s_waitcnt lgkmcnt(8)
    v_mfma_f32_16x16x32_bf16 v[44:47], a[4:7], a[36:39], v[140:143]
    ds_read_b64_tr_b16 a[50:51], v118 offset:4608
    v_mfma_f32_16x16x32_bf16 v[80:83], a[4:7], a[40:43], 0
    ds_read_b128 a[4:7], v113 offset:2048
    s_waitcnt lgkmcnt(9)
    v_mfma_f32_16x16x32_bf16 v[48:51], a[8:11], a[36:39], v[140:143]
    ds_read_b64_tr_b16 a[52:53], v118 offset:12288
    v_mfma_f32_16x16x32_bf16 v[84:87], a[8:11], a[40:43], 0
    ds_read_b128 a[8:11], v113 offset:4096
    s_waitcnt lgkmcnt(10)
    v_mfma_f32_16x16x32_bf16 v[52:55], a[12:15], a[36:39], v[140:143]
    ds_read_b64_tr_b16 a[54:55], v118 offset:12800
    v_mfma_f32_16x16x32_bf16 v[88:91], a[12:15], a[40:43], 0
    ds_read_b128 a[12:15], v113 offset:6144
    s_waitcnt lgkmcnt(11)
    v_mfma_f32_16x16x32_bf16 v[56:59], a[16:19], a[36:39], v[140:143]
    v_mfma_f32_16x16x32_bf16 v[92:95], a[16:19], a[40:43], 0
    ds_read_b128 a[16:19], v113 offset:8192
    s_waitcnt lgkmcnt(11)
    v_mfma_f32_16x16x32_bf16 v[60:63], a[20:23], a[36:39], v[140:143]
    v_mfma_f32_16x16x32_bf16 v[96:99], a[20:23], a[40:43], 0
    ds_read_b128 a[20:23], v113 offset:10240
    s_waitcnt lgkmcnt(11)
    v_mfma_f32_16x16x32_bf16 v[64:67], a[24:27], a[36:39], v[140:143]
    v_mfma_f32_16x16x32_bf16 v[100:103], a[24:27], a[40:43], 0
    ds_read_b128 a[24:27], v113 offset:12288
    s_waitcnt lgkmcnt(11)
    v_mfma_f32_16x16x32_bf16 v[68:71], a[28:31], a[36:39], v[140:143]
    v_mfma_f32_16x16x32_bf16 v[104:107], a[28:31], a[40:43], 0
    ds_read_b128 a[28:31], v113 offset:14336
    s_waitcnt lgkmcnt(5)
    v_mfma_f32_16x16x32_bf16 v[40:43], a[0:3], a[48:51], v[40:43]
    v_mfma_f32_16x16x32_bf16 v[76:79], a[0:3], a[52:55], v[76:79]
    v_mfma_f32_16x16x32_bf16 v[44:47], a[4:7], a[48:51], v[44:47]
    v_mfma_f32_16x16x32_bf16 v[80:83], a[4:7], a[52:55], v[80:83]
    v_mfma_f32_16x16x32_bf16 v[48:51], a[8:11], a[48:51], v[48:51]
    v_mfma_f32_16x16x32_bf16 v[84:87], a[8:11], a[52:55], v[84:87]
    s_waitcnt lgkmcnt(4)
    v_mfma_f32_16x16x32_bf16 v[52:55], a[12:15], a[48:51], v[52:55]
    v_mfma_f32_16x16x32_bf16 v[88:91], a[12:15], a[52:55], v[88:91]
    s_waitcnt lgkmcnt(0)
    s_barrier
    ds_read_b64_tr_b16 a[36:37], v118 offset:16384
    ds_read_b64_tr_b16 a[38:39], v118 offset:16896
    v_mfma_f32_16x16x32_bf16 v[56:59], a[16:19], a[48:51], v[56:59]
    ds_read_b64_tr_b16 a[40:41], v118 offset:24576
    v_mfma_f32_16x16x32_bf16 v[92:95], a[16:19], a[52:55], v[92:95]
    ds_read_b64_tr_b16 a[42:43], v118 offset:25088
    v_mfma_f32_16x16x32_bf16 v[60:63], a[20:23], a[48:51], v[60:63]
    ds_read_b128 a[0:3], v112 offset:16384
    v_mfma_f32_16x16x32_bf16 v[96:99], a[20:23], a[52:55], v[96:99]
    ds_read_b128 a[4:7], v112 offset:18432
    v_mfma_f32_16x16x32_bf16 v[64:67], a[24:27], a[48:51], v[64:67]
    ds_read_b128 a[8:11], v112 offset:20480
    v_mfma_f32_16x16x32_bf16 v[100:103], a[24:27], a[52:55], v[100:103]
    ds_read_b128 a[12:15], v112 offset:22528
    v_mfma_f32_16x16x32_bf16 v[68:71], a[28:31], a[48:51], v[68:71]
    ds_read_b128 a[16:19], v112 offset:24576
    v_mfma_f32_16x16x32_bf16 v[104:107], a[28:31], a[52:55], v[104:107]
    ds_read_b128 a[20:23], v112 offset:26624
    ds_read_b128 a[24:27], v112 offset:28672
    ds_read_b128 a[28:31], v112 offset:30720
    s_waitcnt lgkmcnt(7)
    v_mfma_f32_16x16x32_bf16 v[40:43], a[0:3], a[36:39], v[40:43]
    ds_read_b64_tr_b16 a[48:49], v118 offset:20480
    v_mfma_f32_16x16x32_bf16 v[76:79], a[0:3], a[40:43], v[76:79]
    ds_read_b128 a[0:3], v113 offset:16384
    s_waitcnt lgkmcnt(8)
    v_mfma_f32_16x16x32_bf16 v[44:47], a[4:7], a[36:39], v[44:47]
    ds_read_b64_tr_b16 a[50:51], v118 offset:20992
    v_mfma_f32_16x16x32_bf16 v[80:83], a[4:7], a[40:43], v[80:83]
    ds_read_b128 a[4:7], v113 offset:18432
    s_waitcnt lgkmcnt(9)
    v_mfma_f32_16x16x32_bf16 v[48:51], a[8:11], a[36:39], v[48:51]
    ds_read_b64_tr_b16 a[52:53], v118 offset:28672
    v_mfma_f32_16x16x32_bf16 v[84:87], a[8:11], a[40:43], v[84:87]
    ds_read_b128 a[8:11], v113 offset:20480
    s_waitcnt lgkmcnt(10)
    v_mfma_f32_16x16x32_bf16 v[52:55], a[12:15], a[36:39], v[52:55]
    ds_read_b64_tr_b16 a[54:55], v118 offset:29184
    v_mfma_f32_16x16x32_bf16 v[88:91], a[12:15], a[40:43], v[88:91]
    ds_read_b128 a[12:15], v113 offset:22528
    s_waitcnt lgkmcnt(11)
    v_mfma_f32_16x16x32_bf16 v[56:59], a[16:19], a[36:39], v[56:59]
    v_mfma_f32_16x16x32_bf16 v[92:95], a[16:19], a[40:43], v[92:95]
    ds_read_b128 a[16:19], v113 offset:24576
    s_waitcnt lgkmcnt(11)
    v_mfma_f32_16x16x32_bf16 v[60:63], a[20:23], a[36:39], v[60:63]
    v_mfma_f32_16x16x32_bf16 v[96:99], a[20:23], a[40:43], v[96:99]
    ds_read_b128 a[20:23], v113 offset:26624
    s_waitcnt lgkmcnt(11)
    v_mfma_f32_16x16x32_bf16 v[64:67], a[24:27], a[36:39], v[64:67]
    v_mfma_f32_16x16x32_bf16 v[100:103], a[24:27], a[40:43], v[100:103]
    ds_read_b128 a[24:27], v113 offset:28672
    s_waitcnt lgkmcnt(11)
    v_mfma_f32_16x16x32_bf16 v[68:71], a[28:31], a[36:39], v[68:71]
    v_mfma_f32_16x16x32_bf16 v[104:107], a[28:31], a[40:43], v[104:107]
    ds_read_b128 a[28:31], v113 offset:30720
    s_waitcnt lgkmcnt(5)
    v_mfma_f32_16x16x32_bf16 v[40:43], a[0:3], a[48:51], v[40:43]
    v_mfma_f32_16x16x32_bf16 v[76:79], a[0:3], a[52:55], v[76:79]
    v_mfma_f32_16x16x32_bf16 v[44:47], a[4:7], a[48:51], v[44:47]
    v_mfma_f32_16x16x32_bf16 v[80:83], a[4:7], a[52:55], v[80:83]
    v_mfma_f32_16x16x32_bf16 v[48:51], a[8:11], a[48:51], v[48:51]
    v_mfma_f32_16x16x32_bf16 v[84:87], a[8:11], a[52:55], v[84:87]
    s_waitcnt lgkmcnt(4)
    v_mfma_f32_16x16x32_bf16 v[52:55], a[12:15], a[48:51], v[52:55]
    v_mfma_f32_16x16x32_bf16 v[88:91], a[12:15], a[52:55], v[88:91]
    s_waitcnt lgkmcnt(0)
    s_barrier
    s_cmp_ge_u32 s47, 2
    s_cbranch_scc1 L_wot_1
    s_lshr_b32 s52, s2, 3
    s_lshl_b32 s52, s52, 14
    s_lshl_b32 s53, s47, 13
    s_add_u32 s52, s52, s53
    v_lshlrev_b32 v154, 7, v0
    v_add_u32 v154, s52, v154
    buffer_load_dword v155, v154, s[28:31], 0 offen
L_wot_1:
    ds_read_b64_tr_b16 a[36:37], v118 offset:32768
    ds_read_b64_tr_b16 a[38:39], v118 offset:33280
    v_mfma_f32_16x16x32_bf16 v[56:59], a[16:19], a[48:51], v[56:59]
    ds_read_b64_tr_b16 a[40:41], v118 offset:40960
    v_mfma_f32_16x16x32_bf16 v[92:95], a[16:19], a[52:55], v[92:95]
    ds_read_b64_tr_b16 a[42:43], v118 offset:41472
    v_mfma_f32_16x16x32_bf16 v[60:63], a[20:23], a[48:51], v[60:63]
    ds_read_b128 a[0:3], v112 offset:32768
    v_mfma_f32_16x16x32_bf16 v[96:99], a[20:23], a[52:55], v[96:99]
    ds_read_b128 a[4:7], v112 offset:34816
    v_mfma_f32_16x16x32_bf16 v[64:67], a[24:27], a[48:51], v[64:67]
    ds_read_b128 a[8:11], v112 offset:36864
    v_mfma_f32_16x16x32_bf16 v[100:103], a[24:27], a[52:55], v[100:103]
    ds_read_b128 a[12:15], v112 offset:38912
    v_mfma_f32_16x16x32_bf16 v[68:71], a[28:31], a[48:51], v[68:71]
    ds_read_b128 a[16:19], v112 offset:40960
    v_mfma_f32_16x16x32_bf16 v[104:107], a[28:31], a[52:55], v[104:107]
    ds_read_b128 a[20:23], v112 offset:43008
    ds_read_b128 a[24:27], v112 offset:45056
    ds_read_b128 a[28:31], v112 offset:47104
    s_waitcnt lgkmcnt(7)
    v_mfma_f32_16x16x32_bf16 v[40:43], a[0:3], a[36:39], v[40:43]
    ds_read_b64_tr_b16 a[48:49], v118 offset:36864
    v_mfma_f32_16x16x32_bf16 v[76:79], a[0:3], a[40:43], v[76:79]
    ds_read_b128 a[0:3], v113 offset:32768
    s_waitcnt lgkmcnt(8)
    v_mfma_f32_16x16x32_bf16 v[44:47], a[4:7], a[36:39], v[44:47]
    ds_read_b64_tr_b16 a[50:51], v118 offset:37376
    v_mfma_f32_16x16x32_bf16 v[80:83], a[4:7], a[40:43], v[80:83]
    ds_read_b128 a[4:7], v113 offset:34816
    s_waitcnt lgkmcnt(9)
    v_mfma_f32_16x16x32_bf16 v[48:51], a[8:11], a[36:39], v[48:51]
    ds_read_b64_tr_b16 a[52:53], v118 offset:45056
    v_mfma_f32_16x16x32_bf16 v[84:87], a[8:11], a[40:43], v[84:87]
    ds_read_b128 a[8:11], v113 offset:36864
    s_waitcnt lgkmcnt(10)
    v_mfma_f32_16x16x32_bf16 v[52:55], a[12:15], a[36:39], v[52:55]
    ds_read_b64_tr_b16 a[54:55], v118 offset:45568
    v_mfma_f32_16x16x32_bf16 v[88:91], a[12:15], a[40:43], v[88:91]
    ds_read_b128 a[12:15], v113 offset:38912
    s_waitcnt lgkmcnt(11)
    v_mfma_f32_16x16x32_bf16 v[56:59], a[16:19], a[36:39], v[56:59]
    v_mfma_f32_16x16x32_bf16 v[92:95], a[16:19], a[40:43], v[92:95]
    ds_read_b128 a[16:19], v113 offset:40960
    s_waitcnt lgkmcnt(11)
    v_mfma_f32_16x16x32_bf16 v[60:63], a[20:23], a[36:39], v[60:63]
    v_mfma_f32_16x16x32_bf16 v[96:99], a[20:23], a[40:43], v[96:99]
    ds_read_b128 a[20:23], v113 offset:43008
    s_waitcnt lgkmcnt(11)
    v_mfma_f32_16x16x32_bf16 v[64:67], a[24:27], a[36:39], v[64:67]
    v_mfma_f32_16x16x32_bf16 v[100:103], a[24:27], a[40:43], v[100:103]
    ds_read_b128 a[24:27], v113 offset:45056
    s_waitcnt lgkmcnt(11)
    v_mfma_f32_16x16x32_bf16 v[68:71], a[28:31], a[36:39], v[68:71]
    v_mfma_f32_16x16x32_bf16 v[104:107], a[28:31], a[40:43], v[104:107]
    ds_read_b128 a[28:31], v113 offset:47104
    s_waitcnt lgkmcnt(5)
    v_mfma_f32_16x16x32_bf16 v[40:43], a[0:3], a[48:51], v[40:43]
    v_mfma_f32_16x16x32_bf16 v[76:79], a[0:3], a[52:55], v[76:79]
    v_mfma_f32_16x16x32_bf16 v[44:47], a[4:7], a[48:51], v[44:47]
    v_mfma_f32_16x16x32_bf16 v[80:83], a[4:7], a[52:55], v[80:83]
    v_mfma_f32_16x16x32_bf16 v[48:51], a[8:11], a[48:51], v[48:51]
    v_mfma_f32_16x16x32_bf16 v[84:87], a[8:11], a[52:55], v[84:87]
    s_waitcnt lgkmcnt(4)
    v_mfma_f32_16x16x32_bf16 v[52:55], a[12:15], a[48:51], v[52:55]
    v_mfma_f32_16x16x32_bf16 v[88:91], a[12:15], a[52:55], v[88:91]
    s_waitcnt lgkmcnt(0)
    s_barrier
    ds_read_b64_tr_b16 a[36:37], v118 offset:0
    ds_read_b64_tr_b16 a[38:39], v118 offset:512
    v_mfma_f32_16x16x32_bf16 v[56:59], a[16:19], a[48:51], v[56:59]
    ds_read_b64_tr_b16 a[40:41], v118 offset:8192
    v_mfma_f32_16x16x32_bf16 v[92:95], a[16:19], a[52:55], v[92:95]
    ds_read_b64_tr_b16 a[42:43], v118 offset:8704
    v_mfma_f32_16x16x32_bf16 v[60:63], a[20:23], a[48:51], v[60:63]
    ds_read_b128 a[0:3], v112 offset:49152
    v_mfma_f32_16x16x32_bf16 v[96:99], a[20:23], a[52:55], v[96:99]
    ds_read_b128 a[4:7], v112 offset:51200
    v_mfma_f32_16x16x32_bf16 v[64:67], a[24:27], a[48:51], v[64:67]
    ds_read_b128 a[8:11], v112 offset:53248
    v_mfma_f32_16x16x32_bf16 v[100:103], a[24:27], a[52:55], v[100:103]
    ds_read_b128 a[12:15], v112 offset:55296
    v_mfma_f32_16x16x32_bf16 v[68:71], a[28:31], a[48:51], v[68:71]
    ds_read_b128 a[16:19], v112 offset:57344
    v_mfma_f32_16x16x32_bf16 v[104:107], a[28:31], a[52:55], v[104:107]
    ds_read_b128 a[20:23], v112 offset:59392
    ds_read_b128 a[24:27], v112 offset:61440
    ds_read_b128 a[28:31], v112 offset:63488
    s_waitcnt lgkmcnt(7)
    v_mfma_f32_16x16x32_bf16 v[40:43], a[0:3], a[36:39], v[40:43]
    ds_read_b64_tr_b16 a[48:49], v118 offset:4096
    v_mfma_f32_16x16x32_bf16 v[76:79], a[0:3], a[40:43], v[76:79]
    ds_read_b128 a[0:3], v113 offset:49152
    s_waitcnt lgkmcnt(8)
    v_mfma_f32_16x16x32_bf16 v[44:47], a[4:7], a[36:39], v[44:47]
    ds_read_b64_tr_b16 a[50:51], v118 offset:4608
    v_mfma_f32_16x16x32_bf16 v[80:83], a[4:7], a[40:43], v[80:83]
    ds_read_b128 a[4:7], v113 offset:51200
    s_waitcnt lgkmcnt(9)
    v_mfma_f32_16x16x32_bf16 v[48:51], a[8:11], a[36:39], v[48:51]
    ds_read_b64_tr_b16 a[52:53], v118 offset:12288
    v_mfma_f32_16x16x32_bf16 v[84:87], a[8:11], a[40:43], v[84:87]
    ds_read_b128 a[8:11], v113 offset:53248
    s_waitcnt lgkmcnt(10)
    v_mfma_f32_16x16x32_bf16 v[52:55], a[12:15], a[36:39], v[52:55]
    ds_read_b64_tr_b16 a[54:55], v118 offset:12800
    v_mfma_f32_16x16x32_bf16 v[88:91], a[12:15], a[40:43], v[88:91]
    ds_read_b128 a[12:15], v113 offset:55296
    s_waitcnt lgkmcnt(11)
    v_mfma_f32_16x16x32_bf16 v[56:59], a[16:19], a[36:39], v[56:59]
    v_mfma_f32_16x16x32_bf16 v[92:95], a[16:19], a[40:43], v[92:95]
    ds_read_b128 a[16:19], v113 offset:57344
    s_waitcnt lgkmcnt(11)
    v_mfma_f32_16x16x32_bf16 v[60:63], a[20:23], a[36:39], v[60:63]
    v_mfma_f32_16x16x32_bf16 v[96:99], a[20:23], a[40:43], v[96:99]
    ds_read_b128 a[20:23], v113 offset:59392
    s_waitcnt lgkmcnt(11)
    v_mfma_f32_16x16x32_bf16 v[64:67], a[24:27], a[36:39], v[64:67]
    v_mfma_f32_16x16x32_bf16 v[100:103], a[24:27], a[40:43], v[100:103]
    ds_read_b128 a[24:27], v113 offset:61440
    s_waitcnt lgkmcnt(11)
    v_mfma_f32_16x16x32_bf16 v[68:71], a[28:31], a[36:39], v[68:71]
    v_mfma_f32_16x16x32_bf16 v[104:107], a[28:31], a[40:43], v[104:107]
    ds_read_b128 a[28:31], v113 offset:63488
    s_waitcnt lgkmcnt(5)
    v_mfma_f32_16x16x32_bf16 v[40:43], a[0:3], a[48:51], v[40:43]
    v_mfma_f32_16x16x32_bf16 v[76:79], a[0:3], a[52:55], v[76:79]
    v_mfma_f32_16x16x32_bf16 v[44:47], a[4:7], a[48:51], v[44:47]
    v_mfma_f32_16x16x32_bf16 v[80:83], a[4:7], a[52:55], v[80:83]
    v_mfma_f32_16x16x32_bf16 v[48:51], a[8:11], a[48:51], v[48:51]
    v_mfma_f32_16x16x32_bf16 v[84:87], a[8:11], a[52:55], v[84:87]
    s_waitcnt lgkmcnt(4)
    v_mfma_f32_16x16x32_bf16 v[52:55], a[12:15], a[48:51], v[52:55]
    v_mfma_f32_16x16x32_bf16 v[88:91], a[12:15], a[52:55], v[88:91]
    s_waitcnt lgkmcnt(0)
    s_barrier
    ds_read_b64_tr_b16 a[36:37], v118 offset:16384
    ds_read_b64_tr_b16 a[38:39], v118 offset:16896
    v_mfma_f32_16x16x32_bf16 v[56:59], a[16:19], a[48:51], v[56:59]
    ds_read_b64_tr_b16 a[40:41], v118 offset:24576
    v_mfma_f32_16x16x32_bf16 v[92:95], a[16:19], a[52:55], v[92:95]
    ds_read_b64_tr_b16 a[42:43], v118 offset:25088
    v_mfma_f32_16x16x32_bf16 v[60:63], a[20:23], a[48:51], v[60:63]
    ds_read_b128 a[0:3], v114 offset:0
    v_mfma_f32_16x16x32_bf16 v[96:99], a[20:23], a[52:55], v[96:99]
    ds_read_b128 a[4:7], v114 offset:2048
    v_mfma_f32_16x16x32_bf16 v[64:67], a[24:27], a[48:51], v[64:67]
    ds_read_b128 a[8:11], v114 offset:4096
    v_mfma_f32_16x16x32_bf16 v[100:103], a[24:27], a[52:55], v[100:103]
    ds_read_b128 a[12:15], v114 offset:6144
    v_mfma_f32_16x16x32_bf16 v[68:71], a[28:31], a[48:51], v[68:71]
    ds_read_b128 a[16:19], v114 offset:8192
    v_mfma_f32_16x16x32_bf16 v[104:107], a[28:31], a[52:55], v[104:107]
    ds_read_b128 a[20:23], v114 offset:10240
    ds_read_b128 a[24:27], v114 offset:12288
    ds_read_b128 a[28:31], v114 offset:14336
    s_waitcnt lgkmcnt(7)
    v_mfma_f32_16x16x32_bf16 v[40:43], a[0:3], a[36:39], v[40:43]
    ds_read_b64_tr_b16 a[48:49], v118 offset:20480
    v_mfma_f32_16x16x32_bf16 v[76:79], a[0:3], a[40:43], v[76:79]
    ds_read_b128 a[0:3], v115 offset:0
    s_waitcnt lgkmcnt(8)
    v_mfma_f32_16x16x32_bf16 v[44:47], a[4:7], a[36:39], v[44:47]
    ds_read_b64_tr_b16 a[50:51], v118 offset:20992
    v_mfma_f32_16x16x32_bf16 v[80:83], a[4:7], a[40:43], v[80:83]
    ds_read_b128 a[4:7], v115 offset:2048
    s_waitcnt lgkmcnt(9)
    v_mfma_f32_16x16x32_bf16 v[48:51], a[8:11], a[36:39], v[48:51]
    ds_read_b64_tr_b16 a[52:53], v118 offset:28672
    v_mfma_f32_16x16x32_bf16 v[84:87], a[8:11], a[40:43], v[84:87]
    ds_read_b128 a[8:11], v115 offset:4096
    s_waitcnt lgkmcnt(10)
    v_mfma_f32_16x16x32_bf16 v[52:55], a[12:15], a[36:39], v[52:55]
    ds_read_b64_tr_b16 a[54:55], v118 offset:29184
    v_mfma_f32_16x16x32_bf16 v[88:91], a[12:15], a[40:43], v[88:91]
    ds_read_b128 a[12:15], v115 offset:6144
    s_waitcnt lgkmcnt(11)
    v_mfma_f32_16x16x32_bf16 v[56:59], a[16:19], a[36:39], v[56:59]
    v_mfma_f32_16x16x32_bf16 v[92:95], a[16:19], a[40:43], v[92:95]
    ds_read_b128 a[16:19], v115 offset:8192
    s_waitcnt lgkmcnt(11)
    v_mfma_f32_16x16x32_bf16 v[60:63], a[20:23], a[36:39], v[60:63]
    v_mfma_f32_16x16x32_bf16 v[96:99], a[20:23], a[40:43], v[96:99]
    ds_read_b128 a[20:23], v115 offset:10240
    s_waitcnt lgkmcnt(11)
    v_mfma_f32_16x16x32_bf16 v[64:67], a[24:27], a[36:39], v[64:67]
    v_mfma_f32_16x16x32_bf16 v[100:103], a[24:27], a[40:43], v[100:103]
    ds_read_b128 a[24:27], v115 offset:12288
    s_waitcnt lgkmcnt(11)
    v_mfma_f32_16x16x32_bf16 v[68:71], a[28:31], a[36:39], v[68:71]
    v_mfma_f32_16x16x32_bf16 v[104:107], a[28:31], a[40:43], v[104:107]
    ds_read_b128 a[28:31], v115 offset:14336
    s_waitcnt lgkmcnt(5)
    v_mfma_f32_16x16x32_bf16 v[40:43], a[0:3], a[48:51], v[40:43]
    v_mfma_f32_16x16x32_bf16 v[76:79], a[0:3], a[52:55], v[76:79]
    v_mfma_f32_16x16x32_bf16 v[44:47], a[4:7], a[48:51], v[44:47]
    v_mfma_f32_16x16x32_bf16 v[80:83], a[4:7], a[52:55], v[80:83]
    v_mfma_f32_16x16x32_bf16 v[48:51], a[8:11], a[48:51], v[48:51]
    v_mfma_f32_16x16x32_bf16 v[84:87], a[8:11], a[52:55], v[84:87]
    s_waitcnt lgkmcnt(4)
    v_mfma_f32_16x16x32_bf16 v[52:55], a[12:15], a[48:51], v[52:55]
    v_mfma_f32_16x16x32_bf16 v[88:91], a[12:15], a[52:55], v[88:91]
    s_waitcnt lgkmcnt(0)
    s_barrier
    ds_read_b64_tr_b16 a[36:37], v118 offset:32768
    ds_read_b64_tr_b16 a[38:39], v118 offset:33280
    v_mfma_f32_16x16x32_bf16 v[56:59], a[16:19], a[48:51], v[56:59]
    ds_read_b64_tr_b16 a[40:41], v118 offset:40960
    v_mfma_f32_16x16x32_bf16 v[92:95], a[16:19], a[52:55], v[92:95]
    ds_read_b64_tr_b16 a[42:43], v118 offset:41472
    v_mfma_f32_16x16x32_bf16 v[60:63], a[20:23], a[48:51], v[60:63]
    ds_read_b128 a[0:3], v114 offset:16384
    v_mfma_f32_16x16x32_bf16 v[96:99], a[20:23], a[52:55], v[96:99]
    ds_read_b128 a[4:7], v114 offset:18432
    v_mfma_f32_16x16x32_bf16 v[64:67], a[24:27], a[48:51], v[64:67]
    ds_read_b128 a[8:11], v114 offset:20480
    v_mfma_f32_16x16x32_bf16 v[100:103], a[24:27], a[52:55], v[100:103]
    ds_read_b128 a[12:15], v114 offset:22528
    v_mfma_f32_16x16x32_bf16 v[68:71], a[28:31], a[48:51], v[68:71]
    ds_read_b128 a[16:19], v114 offset:24576
    v_mfma_f32_16x16x32_bf16 v[104:107], a[28:31], a[52:55], v[104:107]
    ds_read_b128 a[20:23], v114 offset:26624
    ds_read_b128 a[24:27], v114 offset:28672
    ds_read_b128 a[28:31], v114 offset:30720
    s_waitcnt lgkmcnt(7)
    v_mfma_f32_16x16x32_bf16 v[40:43], a[0:3], a[36:39], v[40:43]
    ds_read_b64_tr_b16 a[48:49], v118 offset:36864
    v_mfma_f32_16x16x32_bf16 v[76:79], a[0:3], a[40:43], v[76:79]
    ds_read_b128 a[0:3], v115 offset:16384
    s_waitcnt lgkmcnt(8)
    v_mfma_f32_16x16x32_bf16 v[44:47], a[4:7], a[36:39], v[44:47]
    ds_read_b64_tr_b16 a[50:51], v118 offset:37376
    v_mfma_f32_16x16x32_bf16 v[80:83], a[4:7], a[40:43], v[80:83]
    ds_read_b128 a[4:7], v115 offset:18432
    s_waitcnt lgkmcnt(9)
    v_mfma_f32_16x16x32_bf16 v[48:51], a[8:11], a[36:39], v[48:51]
    ds_read_b64_tr_b16 a[52:53], v118 offset:45056
    v_mfma_f32_16x16x32_bf16 v[84:87], a[8:11], a[40:43], v[84:87]
    ds_read_b128 a[8:11], v115 offset:20480
    s_waitcnt lgkmcnt(10)
    v_mfma_f32_16x16x32_bf16 v[52:55], a[12:15], a[36:39], v[52:55]
    ds_read_b64_tr_b16 a[54:55], v118 offset:45568
    v_mfma_f32_16x16x32_bf16 v[88:91], a[12:15], a[40:43], v[88:91]
    ds_read_b128 a[12:15], v115 offset:22528
    s_waitcnt lgkmcnt(11)
    v_mfma_f32_16x16x32_bf16 v[56:59], a[16:19], a[36:39], v[56:59]
    v_mfma_f32_16x16x32_bf16 v[92:95], a[16:19], a[40:43], v[92:95]
    ds_read_b128 a[16:19], v115 offset:24576
    s_waitcnt lgkmcnt(11)
    v_mfma_f32_16x16x32_bf16 v[60:63], a[20:23], a[36:39], v[60:63]
    v_mfma_f32_16x16x32_bf16 v[96:99], a[20:23], a[40:43], v[96:99]
    ds_read_b128 a[20:23], v115 offset:26624
    s_waitcnt lgkmcnt(11)
    v_mfma_f32_16x16x32_bf16 v[64:67], a[24:27], a[36:39], v[64:67]
    v_mfma_f32_16x16x32_bf16 v[100:103], a[24:27], a[40:43], v[100:103]
    ds_read_b128 a[24:27], v115 offset:28672
    s_waitcnt lgkmcnt(11)
    v_mfma_f32_16x16x32_bf16 v[68:71], a[28:31], a[36:39], v[68:71]
    v_mfma_f32_16x16x32_bf16 v[104:107], a[28:31], a[40:43], v[104:107]
    ds_read_b128 a[28:31], v115 offset:30720
    s_waitcnt lgkmcnt(5)
    v_mfma_f32_16x16x32_bf16 v[40:43], a[0:3], a[48:51], v[40:43]
    v_mfma_f32_16x16x32_bf16 v[76:79], a[0:3], a[52:55], v[76:79]
    v_mfma_f32_16x16x32_bf16 v[44:47], a[4:7], a[48:51], v[44:47]
    v_mfma_f32_16x16x32_bf16 v[80:83], a[4:7], a[52:55], v[80:83]
    v_mfma_f32_16x16x32_bf16 v[48:51], a[8:11], a[48:51], v[48:51]
    v_mfma_f32_16x16x32_bf16 v[84:87], a[8:11], a[52:55], v[84:87]
    s_waitcnt lgkmcnt(4)
    v_mfma_f32_16x16x32_bf16 v[52:55], a[12:15], a[48:51], v[52:55]
    v_mfma_f32_16x16x32_bf16 v[88:91], a[12:15], a[52:55], v[88:91]
    s_waitcnt lgkmcnt(0)
    s_barrier
    ds_read_b64_tr_b16 a[36:37], v118 offset:0
    ds_read_b64_tr_b16 a[38:39], v118 offset:512
    v_mfma_f32_16x16x32_bf16 v[56:59], a[16:19], a[48:51], v[56:59]
    ds_read_b64_tr_b16 a[40:41], v118 offset:8192
    v_mfma_f32_16x16x32_bf16 v[92:95], a[16:19], a[52:55], v[92:95]
    ds_read_b64_tr_b16 a[42:43], v118 offset:8704
    v_mfma_f32_16x16x32_bf16 v[60:63], a[20:23], a[48:51], v[60:63]
    ds_read_b128 a[0:3], v114 offset:32768
    v_mfma_f32_16x16x32_bf16 v[96:99], a[20:23], a[52:55], v[96:99]
    ds_read_b128 a[4:7], v114 offset:34816
    v_mfma_f32_16x16x32_bf16 v[64:67], a[24:27], a[48:51], v[64:67]
    ds_read_b128 a[8:11], v114 offset:36864
    v_mfma_f32_16x16x32_bf16 v[100:103], a[24:27], a[52:55], v[100:103]
    ds_read_b128 a[12:15], v114 offset:38912
    v_mfma_f32_16x16x32_bf16 v[68:71], a[28:31], a[48:51], v[68:71]
    ds_read_b128 a[16:19], v114 offset:40960
    v_mfma_f32_16x16x32_bf16 v[104:107], a[28:31], a[52:55], v[104:107]
    ds_read_b128 a[20:23], v114 offset:43008
    ds_read_b128 a[24:27], v114 offset:45056
    ds_read_b128 a[28:31], v114 offset:47104
    s_waitcnt lgkmcnt(7)
    v_mfma_f32_16x16x32_bf16 v[40:43], a[0:3], a[36:39], v[40:43]
    ds_read_b64_tr_b16 a[48:49], v118 offset:4096
    v_mfma_f32_16x16x32_bf16 v[76:79], a[0:3], a[40:43], v[76:79]
    ds_read_b128 a[0:3], v115 offset:32768
    s_waitcnt lgkmcnt(8)
    v_mfma_f32_16x16x32_bf16 v[44:47], a[4:7], a[36:39], v[44:47]
    ds_read_b64_tr_b16 a[50:51], v118 offset:4608
    v_mfma_f32_16x16x32_bf16 v[80:83], a[4:7], a[40:43], v[80:83]
    ds_read_b128 a[4:7], v115 offset:34816
    s_waitcnt lgkmcnt(9)
    v_mfma_f32_16x16x32_bf16 v[48:51], a[8:11], a[36:39], v[48:51]
    ds_read_b64_tr_b16 a[52:53], v118 offset:12288
    v_mfma_f32_16x16x32_bf16 v[84:87], a[8:11], a[40:43], v[84:87]
    ds_read_b128 a[8:11], v115 offset:36864
    s_waitcnt lgkmcnt(10)
    v_mfma_f32_16x16x32_bf16 v[52:55], a[12:15], a[36:39], v[52:55]
    ds_read_b64_tr_b16 a[54:55], v118 offset:12800
    v_mfma_f32_16x16x32_bf16 v[88:91], a[12:15], a[40:43], v[88:91]
    ds_read_b128 a[12:15], v115 offset:38912
    s_waitcnt lgkmcnt(11)
    v_mfma_f32_16x16x32_bf16 v[56:59], a[16:19], a[36:39], v[56:59]
    v_mfma_f32_16x16x32_bf16 v[92:95], a[16:19], a[40:43], v[92:95]
    ds_read_b128 a[16:19], v115 offset:40960
    s_waitcnt lgkmcnt(11)
    v_mfma_f32_16x16x32_bf16 v[60:63], a[20:23], a[36:39], v[60:63]
    v_mfma_f32_16x16x32_bf16 v[96:99], a[20:23], a[40:43], v[96:99]
    ds_read_b128 a[20:23], v115 offset:43008
    s_waitcnt lgkmcnt(11)
    v_mfma_f32_16x16x32_bf16 v[64:67], a[24:27], a[36:39], v[64:67]
    v_mfma_f32_16x16x32_bf16 v[100:103], a[24:27], a[40:43], v[100:103]
    ds_read_b128 a[24:27], v115 offset:45056
    s_waitcnt lgkmcnt(11)
    v_mfma_f32_16x16x32_bf16 v[68:71], a[28:31], a[36:39], v[68:71]
    v_mfma_f32_16x16x32_bf16 v[104:107], a[28:31], a[40:43], v[104:107]
    ds_read_b128 a[28:31], v115 offset:47104
    s_waitcnt lgkmcnt(5)
    v_mfma_f32_16x16x32_bf16 v[40:43], a[0:3], a[48:51], v[40:43]
    v_mfma_f32_16x16x32_bf16 v[76:79], a[0:3], a[52:55], v[76:79]
    v_mfma_f32_16x16x32_bf16 v[44:47], a[4:7], a[48:51], v[44:47]
    v_mfma_f32_16x16x32_bf16 v[80:83], a[4:7], a[52:55], v[80:83]
    v_mfma_f32_16x16x32_bf16 v[48:51], a[8:11], a[48:51], v[48:51]
    v_mfma_f32_16x16x32_bf16 v[84:87], a[8:11], a[52:55], v[84:87]
    s_waitcnt lgkmcnt(4)
    v_mfma_f32_16x16x32_bf16 v[52:55], a[12:15], a[48:51], v[52:55]
    v_mfma_f32_16x16x32_bf16 v[88:91], a[12:15], a[52:55], v[88:91]
    s_waitcnt lgkmcnt(0)
    s_barrier
    ds_read_b64_tr_b16 a[36:37], v118 offset:16384
    ds_read_b64_tr_b16 a[38:39], v118 offset:16896
    v_mfma_f32_16x16x32_bf16 v[56:59], a[16:19], a[48:51], v[56:59]
    ds_read_b64_tr_b16 a[40:41], v118 offset:24576
    v_mfma_f32_16x16x32_bf16 v[92:95], a[16:19], a[52:55], v[92:95]
    ds_read_b64_tr_b16 a[42:43], v118 offset:25088
    v_mfma_f32_16x16x32_bf16 v[60:63], a[20:23], a[48:51], v[60:63]
    ds_read_b128 a[0:3], v112 offset:0
    v_mfma_f32_16x16x32_bf16 v[96:99], a[20:23], a[52:55], v[96:99]
    ds_read_b128 a[4:7], v112 offset:2048
    v_mfma_f32_16x16x32_bf16 v[64:67], a[24:27], a[48:51], v[64:67]
    ds_read_b128 a[8:11], v112 offset:4096
    v_mfma_f32_16x16x32_bf16 v[100:103], a[24:27], a[52:55], v[100:103]
    ds_read_b128 a[12:15], v112 offset:6144
    v_mfma_f32_16x16x32_bf16 v[68:71], a[28:31], a[48:51], v[68:71]
    ds_read_b128 a[16:19], v112 offset:8192
    v_mfma_f32_16x16x32_bf16 v[104:107], a[28:31], a[52:55], v[104:107]
    ds_read_b128 a[20:23], v112 offset:10240
    ds_read_b128 a[24:27], v112 offset:12288
    ds_read_b128 a[28:31], v112 offset:14336
    s_waitcnt lgkmcnt(7)
    v_mfma_f32_16x16x32_bf16 v[40:43], a[0:3], a[36:39], v[40:43]
    ds_read_b64_tr_b16 a[48:49], v118 offset:20480
    v_mfma_f32_16x16x32_bf16 v[76:79], a[0:3], a[40:43], v[76:79]
    ds_read_b128 a[0:3], v113 offset:0
    s_waitcnt lgkmcnt(8)
    v_mfma_f32_16x16x32_bf16 v[44:47], a[4:7], a[36:39], v[44:47]
    ds_read_b64_tr_b16 a[50:51], v118 offset:20992
    v_mfma_f32_16x16x32_bf16 v[80:83], a[4:7], a[40:43], v[80:83]
    ds_read_b128 a[4:7], v113 offset:2048
    s_waitcnt lgkmcnt(9)
    v_mfma_f32_16x16x32_bf16 v[48:51], a[8:11], a[36:39], v[48:51]
    ds_read_b64_tr_b16 a[52:53], v118 offset:28672
    v_mfma_f32_16x16x32_bf16 v[84:87], a[8:11], a[40:43], v[84:87]
    ds_read_b128 a[8:11], v113 offset:4096
    s_waitcnt lgkmcnt(10)
    v_mfma_f32_16x16x32_bf16 v[52:55], a[12:15], a[36:39], v[52:55]
    ds_read_b64_tr_b16 a[54:55], v118 offset:29184
    v_mfma_f32_16x16x32_bf16 v[88:91], a[12:15], a[40:43], v[88:91]
    ds_read_b128 a[12:15], v113 offset:6144
    s_waitcnt lgkmcnt(11)
    v_mfma_f32_16x16x32_bf16 v[56:59], a[16:19], a[36:39], v[56:59]
    v_mfma_f32_16x16x32_bf16 v[92:95], a[16:19], a[40:43], v[92:95]
    ds_read_b128 a[16:19], v113 offset:8192
    s_waitcnt lgkmcnt(11)
    v_mfma_f32_16x16x32_bf16 v[60:63], a[20:23], a[36:39], v[60:63]
    v_mfma_f32_16x16x32_bf16 v[96:99], a[20:23], a[40:43], v[96:99]
    ds_read_b128 a[20:23], v113 offset:10240
    s_waitcnt lgkmcnt(11)
    v_mfma_f32_16x16x32_bf16 v[64:67], a[24:27], a[36:39], v[64:67]
    v_mfma_f32_16x16x32_bf16 v[100:103], a[24:27], a[40:43], v[100:103]
    ds_read_b128 a[24:27], v113 offset:12288
    s_waitcnt lgkmcnt(11)
    v_mfma_f32_16x16x32_bf16 v[68:71], a[28:31], a[36:39], v[68:71]
    v_mfma_f32_16x16x32_bf16 v[104:107], a[28:31], a[40:43], v[104:107]
    ds_read_b128 a[28:31], v113 offset:14336
    s_waitcnt lgkmcnt(5)
    v_mfma_f32_16x16x32_bf16 v[40:43], a[0:3], a[48:51], v[40:43]
    v_mfma_f32_16x16x32_bf16 v[76:79], a[0:3], a[52:55], v[76:79]
    v_mfma_f32_16x16x32_bf16 v[44:47], a[4:7], a[48:51], v[44:47]
    v_mfma_f32_16x16x32_bf16 v[80:83], a[4:7], a[52:55], v[80:83]
    v_mfma_f32_16x16x32_bf16 v[48:51], a[8:11], a[48:51], v[48:51]
    v_mfma_f32_16x16x32_bf16 v[84:87], a[8:11], a[52:55], v[84:87]
    s_waitcnt lgkmcnt(4)
    v_mfma_f32_16x16x32_bf16 v[52:55], a[12:15], a[48:51], v[52:55]
    v_mfma_f32_16x16x32_bf16 v[88:91], a[12:15], a[52:55], v[88:91]
    s_waitcnt lgkmcnt(0)
    s_barrier
    v_mfma_f32_16x16x32_bf16 v[56:59], a[16:19], a[48:51], v[56:59]
    v_mfma_f32_16x16x32_bf16 v[92:95], a[16:19], a[52:55], v[92:95]
    v_mfma_f32_16x16x32_bf16 v[60:63], a[20:23], a[48:51], v[60:63]
    v_mfma_f32_16x16x32_bf16 v[96:99], a[20:23], a[52:55], v[96:99]
    v_mfma_f32_16x16x32_bf16 v[64:67], a[24:27], a[48:51], v[64:67]
    v_mfma_f32_16x16x32_bf16 v[100:103], a[24:27], a[52:55], v[100:103]
    v_mfma_f32_16x16x32_bf16 v[68:71], a[28:31], a[48:51], v[68:71]
    v_mfma_f32_16x16x32_bf16 v[104:107], a[28:31], a[52:55], v[104:107]
    s_lshl_b32 s52, s47, 12
    v_add_u32 v112, s52, v112
    v_add_u32 v113, s52, v113
    v_add_u32 v114, s52, v114
    v_add_u32 v115, s52, v115
    s_lshl_b32 s52, s47, 5
    v_xor_b32 v124, s52, v118
    v_xor_b32 v116, 0, v124
    v_xor_b32 v117, 32, v124
    v_xor_b32 v118, 64, v124
    v_xor_b32 v119, 96, v124
    ds_read_b128 a[0:3], v112 offset:16384
    ds_read_b64_tr_b16 a[16:17], v116 offset:32768
    ds_read_b64_tr_b16 a[18:19], v116 offset:33280
    ds_read_b64_tr_b16 a[20:21], v117 offset:32768
    ds_read_b64_tr_b16 a[22:23], v117 offset:33280
    ds_read_b64_tr_b16 a[24:25], v118 offset:32768
    ds_read_b64_tr_b16 a[26:27], v118 offset:33280
    ds_read_b64_tr_b16 a[28:29], v119 offset:32768
    ds_read_b64_tr_b16 a[30:31], v119 offset:33280
    ds_read_b128 a[4:7], v112 offset:18432
L_kepi:
    v_pk_fma_f32 v[108:109], v[40:41], s[70:71], v[2:3]
    v_pk_fma_f32 v[144:145], v[44:45], s[70:71], v[2:3]
    v_cvt_pk_bf16_f32 v24, v76, v77
    v_pk_fma_f32 v[110:111], v[42:43], s[70:71], v[2:3]
    v_pk_fma_f32 v[146:147], v[46:47], s[70:71], v[2:3]
    v_cvt_pk_bf16_f32 v25, v78, v79
    v_exp_f32_e64 v108, v108 clamp
    v_exp_f32_e64 v144, v144 clamp
    v_cvt_pk_bf16_f32 v26, v80, v81
    v_exp_f32_e64 v109, v109 clamp
    v_exp_f32_e64 v145, v145 clamp
    v_cvt_pk_bf16_f32 v27, v82, v83
    v_exp_f32_e64 v110, v110 clamp
    v_exp_f32_e64 v146, v146 clamp
    v_exp_f32_e64 v111, v111 clamp
    v_exp_f32_e64 v147, v147 clamp
    v_max_f32 v40, s72, v40
    v_max_f32 v44, s72, v44
    v_max_f32 v41, s72, v41
    v_max_f32 v45, s72, v45
    v_max_f32 v42, s72, v42
    v_max_f32 v46, s72, v46
    v_max_f32 v43, s72, v43
    v_max_f32 v47, s72, v47
    v_pk_add_f32 v[40:41], v[40:41], v[108:109]
    v_pk_add_f32 v[44:45], v[44:45], v[144:145]
    v_pk_add_f32 v[42:43], v[42:43], v[110:111]
    v_pk_add_f32 v[46:47], v[46:47], v[146:147]
    v_cvt_pk_bf16_f32 v8, v40, v41
    v_cvt_pk_bf16_f32 v10, v44, v45
    v_cvt_pk_bf16_f32 v9, v42, v43
    v_cvt_pk_bf16_f32 v11, v46, v47
    s_nop 1
    v_mfma_f32_16x16x32_bf16 v[76:79], v[8:11], v[24:27], 0
    v_mfma_f32_16x16x32_bf16 v[80:83], v[72:75], v[8:11], 0
    v_pk_fma_f32 v[108:109], v[48:49], s[70:71], v[2:3]
    v_pk_fma_f32 v[144:145], v[52:53], s[70:71], v[2:3]
    v_cvt_pk_bf16_f32 v28, v84, v85
    v_pk_fma_f32 v[110:111], v[50:51], s[70:71], v[2:3]
    v_pk_fma_f32 v[146:147], v[54:55], s[70:71], v[2:3]
    v_cvt_pk_bf16_f32 v29, v86, v87
    v_exp_f32_e64 v108, v108 clamp
    v_exp_f32_e64 v144, v144 clamp
    v_cvt_pk_bf16_f32 v30, v88, v89
    v_exp_f32_e64 v109, v109 clamp
    v_exp_f32_e64 v145, v145 clamp
    v_cvt_pk_bf16_f32 v31, v90, v91
    v_exp_f32_e64 v110, v110 clamp
    v_exp_f32_e64 v146, v146 clamp
    v_exp_f32_e64 v111, v111 clamp
    v_exp_f32_e64 v147, v147 clamp
    v_max_f32 v48, s72, v48
    v_max_f32 v52, s72, v52
    v_max_f32 v49, s72, v49
    v_max_f32 v53, s72, v53
    v_max_f32 v50, s72, v50
    v_max_f32 v54, s72, v54
    v_max_f32 v51, s72, v51
    v_max_f32 v55, s72, v55
    v_pk_add_f32 v[48:49], v[48:49], v[108:109]
    v_pk_add_f32 v[52:53], v[52:53], v[144:145]
    v_pk_add_f32 v[50:51], v[50:51], v[110:111]
    v_pk_add_f32 v[54:55], v[54:55], v[146:147]
    v_cvt_pk_bf16_f32 v12, v48, v49
    v_cvt_pk_bf16_f32 v14, v52, v53
    v_cvt_pk_bf16_f32 v13, v50, v51
    v_cvt_pk_bf16_f32 v15, v54, v55
    s_nop 1
    v_mfma_f32_16x16x32_bf16 v[76:79], v[12:15], v[28:31], v[76:79]
    v_mfma_f32_16x16x32_bf16 v[80:83], v[72:75], v[12:15], v[80:83]
    v_pk_fma_f32 v[108:109], v[56:57], s[70:71], v[2:3]
    v_pk_fma_f32 v[144:145], v[60:61], s[70:71], v[2:3]
    v_cvt_pk_bf16_f32 v32, v92, v93
    v_pk_fma_f32 v[110:111], v[58:59], s[70:71], v[2:3]
    v_pk_fma_f32 v[146:147], v[62:63], s[70:71], v[2:3]
    v_cvt_pk_bf16_f32 v33, v94, v95
    v_exp_f32_e64 v108, v108 clamp
    v_exp_f32_e64 v144, v144 clamp
    v_cvt_pk_bf16_f32 v34, v96, v97
    v_exp_f32_e64 v109, v109 clamp
    v_exp_f32_e64 v145, v145 clamp
    v_cvt_pk_bf16_f32 v35, v98, v99
    v_exp_f32_e64 v110, v110 clamp
    v_exp_f32_e64 v146, v146 clamp
    v_exp_f32_e64 v111, v111 clamp
    v_exp_f32_e64 v147, v147 clamp
    v_max_f32 v56, s72, v56
    v_max_f32 v60, s72, v60
    v_max_f32 v57, s72, v57
    v_max_f32 v61, s72, v61
    v_max_f32 v58, s72, v58
    v_max_f32 v62, s72, v62
    v_max_f32 v59, s72, v59
    v_max_f32 v63, s72, v63
    v_pk_add_f32 v[56:57], v[56:57], v[108:109]
    v_pk_add_f32 v[60:61], v[60:61], v[144:145]
    v_pk_add_f32 v[58:59], v[58:59], v[110:111]
    v_pk_add_f32 v[62:63], v[62:63], v[146:147]
    v_cvt_pk_bf16_f32 v16, v56, v57
    v_cvt_pk_bf16_f32 v18, v60, v61
    v_cvt_pk_bf16_f32 v17, v58, v59
    v_cvt_pk_bf16_f32 v19, v62, v63
    s_nop 1
    v_mfma_f32_16x16x32_bf16 v[76:79], v[16:19], v[32:35], v[76:79]
    v_mfma_f32_16x16x32_bf16 v[80:83], v[72:75], v[16:19], v[80:83]
    v_pk_fma_f32 v[108:109], v[64:65], s[70:71], v[2:3]
    v_pk_fma_f32 v[144:145], v[68:69], s[70:71], v[2:3]
    v_cvt_pk_bf16_f32 v36, v100, v101
    v_pk_fma_f32 v[110:111], v[66:67], s[70:71], v[2:3]
    v_pk_fma_f32 v[146:147], v[70:71], s[70:71], v[2:3]
    v_cvt_pk_bf16_f32 v37, v102, v103
    v_exp_f32_e64 v108, v108 clamp
    v_exp_f32_e64 v144, v144 clamp
    v_cvt_pk_bf16_f32 v38, v104, v105
    v_exp_f32_e64 v109, v109 clamp
    v_exp_f32_e64 v145, v145 clamp
    v_cvt_pk_bf16_f32 v39, v106, v107
    v_exp_f32_e64 v110, v110 clamp
    v_exp_f32_e64 v146, v146 clamp
    v_exp_f32_e64 v111, v111 clamp
    v_exp_f32_e64 v147, v147 clamp
    v_max_f32 v64, s72, v64
    v_max_f32 v68, s72, v68
    v_max_f32 v65, s72, v65
    v_max_f32 v69, s72, v69
    v_max_f32 v66, s72, v66
    v_max_f32 v70, s72, v70
    v_max_f32 v67, s72, v67
    v_max_f32 v71, s72, v71
    v_pk_add_f32 v[64:65], v[64:65], v[108:109]
    v_pk_add_f32 v[68:69], v[68:69], v[144:145]
    v_pk_add_f32 v[66:67], v[66:67], v[110:111]
    v_pk_add_f32 v[70:71], v[70:71], v[146:147]
    v_cvt_pk_bf16_f32 v20, v64, v65
    v_cvt_pk_bf16_f32 v22, v68, v69
    v_cvt_pk_bf16_f32 v21, v66, v67
    v_cvt_pk_bf16_f32 v23, v70, v71
    s_nop 1
    v_mfma_f32_16x16x32_bf16 v[76:79], v[20:23], v[36:39], v[76:79]
    v_mfma_f32_16x16x32_bf16 v[80:83], v[72:75], v[20:23], v[80:83]
    s_nop 6
    buffer_atomic_add_f32 v76, v6, s[36:39], 0 offen offset:0 sc1
    buffer_atomic_add_f32 v77, v6, s[36:39], 0 offen offset:256 sc1
    buffer_atomic_add_f32 v78, v6, s[36:39], 0 offen offset:512 sc1
    buffer_atomic_add_f32 v79, v6, s[36:39], 0 offen offset:768 sc1
    s_mov_b64 s[68:69], exec
    s_mov_b64 exec, 0xffff
    buffer_atomic_add_f32 v80, v5, s[36:39], 0 offen sc1
    s_mov_b64 exec, s[68:69]
    s_waitcnt lgkmcnt(7)
    v_mfma_f32_16x16x32_bf16 v[8:11], a[16:19], a[0:3], v[140:143]
    ds_read_b128 a[8:11], v113 offset:16384
    ds_read_b64_tr_b16 a[32:33], v116 offset:36864
    s_waitcnt lgkmcnt(7)
    v_mfma_f32_16x16x32_bf16 v[16:19], a[20:23], a[0:3], v[140:143]
    ds_read_b64_tr_b16 a[34:35], v116 offset:37376
    ds_read_b64_tr_b16 a[36:37], v117 offset:36864
    s_waitcnt lgkmcnt(7)
    v_mfma_f32_16x16x32_bf16 v[24:27], a[24:27], a[0:3], v[140:143]
    ds_read_b64_tr_b16 a[38:39], v117 offset:37376
    ds_read_b64_tr_b16 a[40:41], v118 offset:36864
    s_waitcnt lgkmcnt(7)
    v_mfma_f32_16x16x32_bf16 v[32:35], a[28:31], a[0:3], v[140:143]
    ds_read_b64_tr_b16 a[42:43], v118 offset:37376
    ds_read_b64_tr_b16 a[44:45], v119 offset:36864
    s_waitcnt lgkmcnt(8)
    v_mfma_f32_16x16x32_bf16 v[12:15], a[16:19], a[4:7], v[140:143]
    ds_read_b64_tr_b16 a[46:47], v119 offset:37376
    ds_read_b128 a[12:15], v113 offset:18432
    v_mfma_f32_16x16x32_bf16 v[20:23], a[20:23], a[4:7], v[140:143]
    v_mfma_f32_16x16x32_bf16 v[28:31], a[24:27], a[4:7], v[140:143]
    v_mfma_f32_16x16x32_bf16 v[36:39], a[28:31], a[4:7], v[140:143]
    s_waitcnt lgkmcnt(7)
    v_mfma_f32_16x16x32_bf16 v[8:11], a[32:35], a[8:11], v[8:11]
    ds_read_b128 a[0:3], v112 offset:32768
    ds_read_b64_tr_b16 a[16:17], v116 offset:40960
    s_waitcnt lgkmcnt(7)
    v_mfma_f32_16x16x32_bf16 v[16:19], a[36:39], a[8:11], v[16:19]
    ds_read_b64_tr_b16 a[18:19], v116 offset:41472
    ds_read_b64_tr_b16 a[20:21], v117 offset:40960
    s_waitcnt lgkmcnt(7)
    v_mfma_f32_16x16x32_bf16 v[24:27], a[40:43], a[8:11], v[24:27]
    ds_read_b64_tr_b16 a[22:23], v117 offset:41472
    ds_read_b64_tr_b16 a[24:25], v118 offset:40960
    s_waitcnt lgkmcnt(7)
    v_mfma_f32_16x16x32_bf16 v[32:35], a[44:47], a[8:11], v[32:35]
    ds_read_b64_tr_b16 a[26:27], v118 offset:41472
    ds_read_b64_tr_b16 a[28:29], v119 offset:40960
    s_waitcnt lgkmcnt(8)
    v_mfma_f32_16x16x32_bf16 v[12:15], a[32:35], a[12:15], v[12:15]
    ds_read_b64_tr_b16 a[30:31], v119 offset:41472
    ds_read_b128 a[4:7], v112 offset:34816
    v_mfma_f32_16x16x32_bf16 v[20:23], a[36:39], a[12:15], v[20:23]
    v_mfma_f32_16x16x32_bf16 v[28:31], a[40:43], a[12:15], v[28:31]
    v_mfma_f32_16x16x32_bf16 v[36:39], a[44:47], a[12:15], v[36:39]
    s_waitcnt lgkmcnt(7)
    v_mfma_f32_16x16x32_bf16 v[8:11], a[16:19], a[0:3], v[8:11]
    ds_read_b128 a[8:11], v113 offset:32768
    ds_read_b64_tr_b16 a[32:33], v116 offset:45056
    s_waitcnt lgkmcnt(7)
    v_mfma_f32_16x16x32_bf16 v[16:19], a[20:23], a[0:3], v[16:19]
    ds_read_b64_tr_b16 a[34:35], v116 offset:45568
    ds_read_b64_tr_b16 a[36:37], v117 offset:45056
    s_waitcnt lgkmcnt(7)
    v_mfma_f32_16x16x32_bf16 v[24:27], a[24:27], a[0:3], v[24:27]
    ds_read_b64_tr_b16 a[38:39], v117 offset:45568
    ds_read_b64_tr_b16 a[40:41], v118 offset:45056
    s_waitcnt lgkmcnt(7)
    v_mfma_f32_16x16x32_bf16 v[32:35], a[28:31], a[0:3], v[32:35]
    ds_read_b64_tr_b16 a[42:43], v118 offset:45568
    ds_read_b64_tr_b16 a[44:45], v119 offset:45056
    s_waitcnt lgkmcnt(8)
    v_mfma_f32_16x16x32_bf16 v[12:15], a[16:19], a[4:7], v[12:15]
    ds_read_b64_tr_b16 a[46:47], v119 offset:45568
    ds_read_b128 a[12:15], v113 offset:34816
    v_mfma_f32_16x16x32_bf16 v[20:23], a[20:23], a[4:7], v[20:23]
    v_mfma_f32_16x16x32_bf16 v[28:31], a[24:27], a[4:7], v[28:31]
    v_mfma_f32_16x16x32_bf16 v[36:39], a[28:31], a[4:7], v[36:39]
    s_waitcnt lgkmcnt(7)
    v_mfma_f32_16x16x32_bf16 v[8:11], a[32:35], a[8:11], v[8:11]
    s_waitcnt lgkmcnt(5)
    v_mfma_f32_16x16x32_bf16 v[16:19], a[36:39], a[8:11], v[16:19]
    s_waitcnt lgkmcnt(3)
    v_mfma_f32_16x16x32_bf16 v[24:27], a[40:43], a[8:11], v[24:27]
    s_waitcnt lgkmcnt(1)
    v_mfma_f32_16x16x32_bf16 v[32:35], a[44:47], a[8:11], v[32:35]
    s_waitcnt lgkmcnt(0)
    s_barrier
    ds_read_b128 a[0:3], v112 offset:49152
    ds_read_b64_tr_b16 a[16:17], v116 offset:0
    ds_read_b64_tr_b16 a[18:19], v116 offset:512
    v_mfma_f32_16x16x32_bf16 v[12:15], a[32:35], a[12:15], v[12:15]
    ds_read_b64_tr_b16 a[20:21], v117 offset:0
    ds_read_b64_tr_b16 a[22:23], v117 offset:512
    ds_read_b64_tr_b16 a[24:25], v118 offset:0
    v_mfma_f32_16x16x32_bf16 v[20:23], a[36:39], a[12:15], v[20:23]
    ds_read_b64_tr_b16 a[26:27], v118 offset:512
    ds_read_b64_tr_b16 a[28:29], v119 offset:0
    ds_read_b64_tr_b16 a[30:31], v119 offset:512
    v_mfma_f32_16x16x32_bf16 v[28:31], a[40:43], a[12:15], v[28:31]
    ds_read_b128 a[4:7], v112 offset:51200
    v_mfma_f32_16x16x32_bf16 v[36:39], a[44:47], a[12:15], v[36:39]
    s_waitcnt lgkmcnt(7)
    v_mfma_f32_16x16x32_bf16 v[8:11], a[16:19], a[0:3], v[8:11]
    ds_read_b128 a[8:11], v113 offset:49152
    ds_read_b64_tr_b16 a[32:33], v116 offset:4096
    s_waitcnt lgkmcnt(7)
    v_mfma_f32_16x16x32_bf16 v[16:19], a[20:23], a[0:3], v[16:19]
    ds_read_b64_tr_b16 a[34:35], v116 offset:4608
    ds_read_b64_tr_b16 a[36:37], v117 offset:4096
    s_waitcnt lgkmcnt(7)
    v_mfma_f32_16x16x32_bf16 v[24:27], a[24:27], a[0:3], v[24:27]
    ds_read_b64_tr_b16 a[38:39], v117 offset:4608
    ds_read_b64_tr_b16 a[40:41], v118 offset:4096
    s_waitcnt lgkmcnt(7)
    v_mfma_f32_16x16x32_bf16 v[32:35], a[28:31], a[0:3], v[32:35]
    ds_read_b64_tr_b16 a[42:43], v118 offset:4608
    ds_read_b64_tr_b16 a[44:45], v119 offset:4096
    s_waitcnt lgkmcnt(8)
    v_mfma_f32_16x16x32_bf16 v[12:15], a[16:19], a[4:7], v[12:15]
    ds_read_b64_tr_b16 a[46:47], v119 offset:4608
    ds_read_b128 a[12:15], v113 offset:51200
    v_mfma_f32_16x16x32_bf16 v[20:23], a[20:23], a[4:7], v[20:23]
    v_mfma_f32_16x16x32_bf16 v[28:31], a[24:27], a[4:7], v[28:31]
    v_mfma_f32_16x16x32_bf16 v[36:39], a[28:31], a[4:7], v[36:39]
    s_waitcnt lgkmcnt(7)
    v_mfma_f32_16x16x32_bf16 v[8:11], a[32:35], a[8:11], v[8:11]
    ds_read_b128 a[0:3], v114 offset:0
    ds_read_b64_tr_b16 a[16:17], v116 offset:8192
    s_waitcnt lgkmcnt(7)
    v_mfma_f32_16x16x32_bf16 v[16:19], a[36:39], a[8:11], v[16:19]
    ds_read_b64_tr_b16 a[18:19], v116 offset:8704
    ds_read_b64_tr_b16 a[20:21], v117 offset:8192
    s_waitcnt lgkmcnt(7)
    v_mfma_f32_16x16x32_bf16 v[24:27], a[40:43], a[8:11], v[24:27]
    ds_read_b64_tr_b16 a[22:23], v117 offset:8704
    ds_read_b64_tr_b16 a[24:25], v118 offset:8192
    s_waitcnt lgkmcnt(7)
    v_mfma_f32_16x16x32_bf16 v[32:35], a[44:47], a[8:11], v[32:35]
    ds_read_b64_tr_b16 a[26:27], v118 offset:8704
    ds_read_b64_tr_b16 a[28:29], v119 offset:8192
    s_waitcnt lgkmcnt(8)
    v_mfma_f32_16x16x32_bf16 v[12:15], a[32:35], a[12:15], v[12:15]
    ds_read_b64_tr_b16 a[30:31], v119 offset:8704
    ds_read_b128 a[4:7], v114 offset:2048
    v_mfma_f32_16x16x32_bf16 v[20:23], a[36:39], a[12:15], v[20:23]
    v_mfma_f32_16x16x32_bf16 v[28:31], a[40:43], a[12:15], v[28:31]
    v_mfma_f32_16x16x32_bf16 v[36:39], a[44:47], a[12:15], v[36:39]
    s_waitcnt lgkmcnt(7)
    v_mfma_f32_16x16x32_bf16 v[8:11], a[16:19], a[0:3], v[8:11]
    ds_read_b128 a[8:11], v115 offset:0
    ds_read_b64_tr_b16 a[32:33], v116 offset:12288
    s_waitcnt lgkmcnt(7)
    v_mfma_f32_16x16x32_bf16 v[16:19], a[20:23], a[0:3], v[16:19]
    ds_read_b64_tr_b16 a[34:35], v116 offset:12800
    ds_read_b64_tr_b16 a[36:37], v117 offset:12288
    s_waitcnt lgkmcnt(7)
    v_mfma_f32_16x16x32_bf16 v[24:27], a[24:27], a[0:3], v[24:27]
    ds_read_b64_tr_b16 a[38:39], v117 offset:12800
    ds_read_b64_tr_b16 a[40:41], v118 offset:12288
    s_waitcnt lgkmcnt(7)
    v_mfma_f32_16x16x32_bf16 v[32:35], a[28:31], a[0:3], v[32:35]
    ds_read_b64_tr_b16 a[42:43], v118 offset:12800
    ds_read_b64_tr_b16 a[44:45], v119 offset:12288
    s_waitcnt lgkmcnt(8)
    v_mfma_f32_16x16x32_bf16 v[12:15], a[16:19], a[4:7], v[12:15]
    ds_read_b64_tr_b16 a[46:47], v119 offset:12800
    ds_read_b128 a[12:15], v115 offset:2048
    v_mfma_f32_16x16x32_bf16 v[20:23], a[20:23], a[4:7], v[20:23]
    v_mfma_f32_16x16x32_bf16 v[28:31], a[24:27], a[4:7], v[28:31]
    v_mfma_f32_16x16x32_bf16 v[36:39], a[28:31], a[4:7], v[36:39]
    s_waitcnt lgkmcnt(7)
    v_mfma_f32_16x16x32_bf16 v[8:11], a[32:35], a[8:11], v[8:11]
    s_waitcnt lgkmcnt(5)
    v_mfma_f32_16x16x32_bf16 v[16:19], a[36:39], a[8:11], v[16:19]
    s_waitcnt lgkmcnt(3)
    v_mfma_f32_16x16x32_bf16 v[24:27], a[40:43], a[8:11], v[24:27]
    s_waitcnt lgkmcnt(1)
    v_mfma_f32_16x16x32_bf16 v[32:35], a[44:47], a[8:11], v[32:35]
    s_waitcnt vmcnt(0)
    s_waitcnt lgkmcnt(0)
    s_barrier
    ds_read_b128 a[0:3], v114 offset:16384
    ds_read_b64_tr_b16 a[16:17], v116 offset:16384
    ds_read_b64_tr_b16 a[18:19], v116 offset:16896
    v_mfma_f32_16x16x32_bf16 v[12:15], a[32:35], a[12:15], v[12:15]
    ds_read_b64_tr_b16 a[20:21], v117 offset:16384
    ds_read_b64_tr_b16 a[22:23], v117 offset:16896
    ds_read_b64_tr_b16 a[24:25], v118 offset:16384
    v_mfma_f32_16x16x32_bf16 v[20:23], a[36:39], a[12:15], v[20:23]
    ds_read_b64_tr_b16 a[26:27], v118 offset:16896
    ds_read_b64_tr_b16 a[28:29], v119 offset:16384
    ds_read_b64_tr_b16 a[30:31], v119 offset:16896
    v_mfma_f32_16x16x32_bf16 v[28:31], a[40:43], a[12:15], v[28:31]
    ds_read_b128 a[4:7], v114 offset:18432
    v_mfma_f32_16x16x32_bf16 v[36:39], a[44:47], a[12:15], v[36:39]
    s_waitcnt lgkmcnt(7)
    v_mfma_f32_16x16x32_bf16 v[8:11], a[16:19], a[0:3], v[8:11]
    ds_read_b128 a[8:11], v115 offset:16384
    ds_read_b64_tr_b16 a[32:33], v116 offset:20480
    s_waitcnt lgkmcnt(7)
    v_mfma_f32_16x16x32_bf16 v[16:19], a[20:23], a[0:3], v[16:19]
    ds_read_b64_tr_b16 a[34:35], v116 offset:20992
    ds_read_b64_tr_b16 a[36:37], v117 offset:20480
    s_waitcnt lgkmcnt(7)
    v_mfma_f32_16x16x32_bf16 v[24:27], a[24:27], a[0:3], v[24:27]
    ds_read_b64_tr_b16 a[38:39], v117 offset:20992
    ds_read_b64_tr_b16 a[40:41], v118 offset:20480
    s_waitcnt lgkmcnt(7)
    v_mfma_f32_16x16x32_bf16 v[32:35], a[28:31], a[0:3], v[32:35]
    ds_read_b64_tr_b16 a[42:43], v118 offset:20992
    ds_read_b64_tr_b16 a[44:45], v119 offset:20480
    s_waitcnt lgkmcnt(8)
    v_mfma_f32_16x16x32_bf16 v[12:15], a[16:19], a[4:7], v[12:15]
    ds_read_b64_tr_b16 a[46:47], v119 offset:20992
    ds_read_b128 a[12:15], v115 offset:18432
    v_mfma_f32_16x16x32_bf16 v[20:23], a[20:23], a[4:7], v[20:23]
    v_mfma_f32_16x16x32_bf16 v[28:31], a[24:27], a[4:7], v[28:31]
    v_mfma_f32_16x16x32_bf16 v[36:39], a[28:31], a[4:7], v[36:39]
    s_waitcnt lgkmcnt(7)
    v_mfma_f32_16x16x32_bf16 v[8:11], a[32:35], a[8:11], v[8:11]
    ds_read_b128 a[0:3], v114 offset:32768
    ds_read_b64_tr_b16 a[16:17], v116 offset:24576
    s_waitcnt lgkmcnt(7)
    v_mfma_f32_16x16x32_bf16 v[16:19], a[36:39], a[8:11], v[16:19]
    ds_read_b64_tr_b16 a[18:19], v116 offset:25088
    ds_read_b64_tr_b16 a[20:21], v117 offset:24576
    s_waitcnt lgkmcnt(7)
    v_mfma_f32_16x16x32_bf16 v[24:27], a[40:43], a[8:11], v[24:27]
    ds_read_b64_tr_b16 a[22:23], v117 offset:25088
    ds_read_b64_tr_b16 a[24:25], v118 offset:24576
    s_waitcnt lgkmcnt(7)
    v_mfma_f32_16x16x32_bf16 v[32:35], a[44:47], a[8:11], v[32:35]
    ds_read_b64_tr_b16 a[26:27], v118 offset:25088
    ds_read_b64_tr_b16 a[28:29], v119 offset:24576
    s_waitcnt lgkmcnt(8)
    v_mfma_f32_16x16x32_bf16 v[12:15], a[32:35], a[12:15], v[12:15]
    ds_read_b64_tr_b16 a[30:31], v119 offset:25088
    ds_read_b128 a[4:7], v114 offset:34816
    v_mfma_f32_16x16x32_bf16 v[20:23], a[36:39], a[12:15], v[20:23]
    v_mfma_f32_16x16x32_bf16 v[28:31], a[40:43], a[12:15], v[28:31]
    v_mfma_f32_16x16x32_bf16 v[36:39], a[44:47], a[12:15], v[36:39]
    s_waitcnt lgkmcnt(7)
    v_mfma_f32_16x16x32_bf16 v[8:11], a[16:19], a[0:3], v[8:11]
    ds_read_b128 a[8:11], v115 offset:32768
    ds_read_b64_tr_b16 a[32:33], v116 offset:28672
    s_waitcnt lgkmcnt(7)
    v_mfma_f32_16x16x32_bf16 v[16:19], a[20:23], a[0:3], v[16:19]
    ds_read_b64_tr_b16 a[34:35], v116 offset:29184
    ds_read_b64_tr_b16 a[36:37], v117 offset:28672
    s_waitcnt lgkmcnt(7)
    v_mfma_f32_16x16x32_bf16 v[24:27], a[24:27], a[0:3], v[24:27]
    ds_read_b64_tr_b16 a[38:39], v117 offset:29184
    ds_read_b64_tr_b16 a[40:41], v118 offset:28672
    s_waitcnt lgkmcnt(7)
    v_mfma_f32_16x16x32_bf16 v[32:35], a[28:31], a[0:3], v[32:35]
    ds_read_b64_tr_b16 a[42:43], v118 offset:29184
    ds_read_b64_tr_b16 a[44:45], v119 offset:28672
    s_waitcnt lgkmcnt(8)
    v_mfma_f32_16x16x32_bf16 v[12:15], a[16:19], a[4:7], v[12:15]
    ds_read_b64_tr_b16 a[46:47], v119 offset:29184
    ds_read_b128 a[12:15], v115 offset:34816
    v_mfma_f32_16x16x32_bf16 v[20:23], a[20:23], a[4:7], v[20:23]
    v_mfma_f32_16x16x32_bf16 v[28:31], a[24:27], a[4:7], v[28:31]
    v_mfma_f32_16x16x32_bf16 v[36:39], a[28:31], a[4:7], v[36:39]
    s_waitcnt lgkmcnt(7)
    v_mfma_f32_16x16x32_bf16 v[8:11], a[32:35], a[8:11], v[8:11]
    s_waitcnt lgkmcnt(5)
    v_mfma_f32_16x16x32_bf16 v[16:19], a[36:39], a[8:11], v[16:19]
    s_waitcnt lgkmcnt(3)
    v_mfma_f32_16x16x32_bf16 v[24:27], a[40:43], a[8:11], v[24:27]
    s_waitcnt lgkmcnt(1)
    v_mfma_f32_16x16x32_bf16 v[32:35], a[44:47], a[8:11], v[32:35]
    s_waitcnt lgkmcnt(0)
    s_barrier
    ds_read_b128 a[0:3], v112 offset:0
    ds_read_b64_tr_b16 a[16:17], v116 offset:32768
    ds_read_b64_tr_b16 a[18:19], v116 offset:33280
    v_mfma_f32_16x16x32_bf16 v[12:15], a[32:35], a[12:15], v[12:15]
    ds_read_b64_tr_b16 a[20:21], v117 offset:32768
    ds_read_b64_tr_b16 a[22:23], v117 offset:33280
    ds_read_b64_tr_b16 a[24:25], v118 offset:32768
    v_mfma_f32_16x16x32_bf16 v[20:23], a[36:39], a[12:15], v[20:23]
    ds_read_b64_tr_b16 a[26:27], v118 offset:33280
    ds_read_b64_tr_b16 a[28:29], v119 offset:32768
    ds_read_b64_tr_b16 a[30:31], v119 offset:33280
    v_mfma_f32_16x16x32_bf16 v[28:31], a[40:43], a[12:15], v[28:31]
    ds_read_b128 a[4:7], v112 offset:2048
    v_mfma_f32_16x16x32_bf16 v[36:39], a[44:47], a[12:15], v[36:39]
    s_waitcnt lgkmcnt(7)
    v_mfma_f32_16x16x32_bf16 v[8:11], a[16:19], a[0:3], v[8:11]
    ds_read_b128 a[8:11], v113 offset:0
    ds_read_b64_tr_b16 a[32:33], v116 offset:36864
    s_waitcnt lgkmcnt(7)
    v_mfma_f32_16x16x32_bf16 v[16:19], a[20:23], a[0:3], v[16:19]
    ds_read_b64_tr_b16 a[34:35], v116 offset:37376
    ds_read_b64_tr_b16 a[36:37], v117 offset:36864
    s_waitcnt lgkmcnt(7)
    v_mfma_f32_16x16x32_bf16 v[24:27], a[24:27], a[0:3], v[24:27]
    ds_read_b64_tr_b16 a[38:39], v117 offset:37376
    ds_read_b64_tr_b16 a[40:41], v118 offset:36864
    s_waitcnt lgkmcnt(7)
    v_mfma_f32_16x16x32_bf16 v[32:35], a[28:31], a[0:3], v[32:35]
    ds_read_b64_tr_b16 a[42:43], v118 offset:37376
    ds_read_b64_tr_b16 a[44:45], v119 offset:36864
    s_waitcnt lgkmcnt(8)
    v_mfma_f32_16x16x32_bf16 v[12:15], a[16:19], a[4:7], v[12:15]
    ds_read_b64_tr_b16 a[46:47], v119 offset:37376
    ds_read_b128 a[12:15], v113 offset:2048
    v_mfma_f32_16x16x32_bf16 v[20:23], a[20:23], a[4:7], v[20:23]
    v_mfma_f32_16x16x32_bf16 v[28:31], a[24:27], a[4:7], v[28:31]
    v_mfma_f32_16x16x32_bf16 v[36:39], a[28:31], a[4:7], v[36:39]
    s_waitcnt lgkmcnt(7)
    v_mfma_f32_16x16x32_bf16 v[8:11], a[32:35], a[8:11], v[8:11]
    ds_read_b128 a[0:3], v112 offset:16384
    ds_read_b64_tr_b16 a[16:17], v116 offset:40960
    s_waitcnt lgkmcnt(7)
    v_mfma_f32_16x16x32_bf16 v[16:19], a[36:39], a[8:11], v[16:19]
    ds_read_b64_tr_b16 a[18:19], v116 offset:41472
    ds_read_b64_tr_b16 a[20:21], v117 offset:40960
    s_waitcnt lgkmcnt(7)
    v_mfma_f32_16x16x32_bf16 v[24:27], a[40:43], a[8:11], v[24:27]
    ds_read_b64_tr_b16 a[22:23], v117 offset:41472
    ds_read_b64_tr_b16 a[24:25], v118 offset:40960
    s_waitcnt lgkmcnt(7)
    v_mfma_f32_16x16x32_bf16 v[32:35], a[44:47], a[8:11], v[32:35]
    ds_read_b64_tr_b16 a[26:27], v118 offset:41472
    ds_read_b64_tr_b16 a[28:29], v119 offset:40960
    s_waitcnt lgkmcnt(8)
    v_mfma_f32_16x16x32_bf16 v[12:15], a[32:35], a[12:15], v[12:15]
    ds_read_b64_tr_b16 a[30:31], v119 offset:41472
    ds_read_b128 a[4:7], v112 offset:18432
    v_mfma_f32_16x16x32_bf16 v[20:23], a[36:39], a[12:15], v[20:23]
    v_mfma_f32_16x16x32_bf16 v[28:31], a[40:43], a[12:15], v[28:31]
    v_mfma_f32_16x16x32_bf16 v[36:39], a[44:47], a[12:15], v[36:39]
    s_waitcnt lgkmcnt(7)
    v_mfma_f32_16x16x32_bf16 v[8:11], a[16:19], a[0:3], v[8:11]
    ds_read_b128 a[8:11], v113 offset:16384
    ds_read_b64_tr_b16 a[32:33], v116 offset:45056
    s_waitcnt lgkmcnt(7)
    v_mfma_f32_16x16x32_bf16 v[16:19], a[20:23], a[0:3], v[16:19]
    ds_read_b64_tr_b16 a[34:35], v116 offset:45568
    ds_read_b64_tr_b16 a[36:37], v117 offset:45056
    s_waitcnt lgkmcnt(7)
    v_mfma_f32_16x16x32_bf16 v[24:27], a[24:27], a[0:3], v[24:27]
    ds_read_b64_tr_b16 a[38:39], v117 offset:45568
    ds_read_b64_tr_b16 a[40:41], v118 offset:45056
    s_waitcnt lgkmcnt(7)
    v_mfma_f32_16x16x32_bf16 v[32:35], a[28:31], a[0:3], v[32:35]
    ds_read_b64_tr_b16 a[42:43], v118 offset:45568
    ds_read_b64_tr_b16 a[44:45], v119 offset:45056
    s_waitcnt lgkmcnt(8)
    v_mfma_f32_16x16x32_bf16 v[12:15], a[16:19], a[4:7], v[12:15]
    ds_read_b64_tr_b16 a[46:47], v119 offset:45568
    ds_read_b128 a[12:15], v113 offset:18432
    v_mfma_f32_16x16x32_bf16 v[20:23], a[20:23], a[4:7], v[20:23]
    v_mfma_f32_16x16x32_bf16 v[28:31], a[24:27], a[4:7], v[28:31]
    v_mfma_f32_16x16x32_bf16 v[36:39], a[28:31], a[4:7], v[36:39]
    s_waitcnt lgkmcnt(7)
    v_mfma_f32_16x16x32_bf16 v[8:11], a[32:35], a[8:11], v[8:11]
    s_waitcnt lgkmcnt(5)
    v_mfma_f32_16x16x32_bf16 v[16:19], a[36:39], a[8:11], v[16:19]
    s_waitcnt lgkmcnt(3)
    v_mfma_f32_16x16x32_bf16 v[24:27], a[40:43], a[8:11], v[24:27]
    s_waitcnt lgkmcnt(1)
    v_mfma_f32_16x16x32_bf16 v[32:35], a[44:47], a[8:11], v[32:35]
    s_waitcnt lgkmcnt(0)
    s_barrier
    v_mfma_f32_16x16x32_bf16 v[12:15], a[32:35], a[12:15], v[12:15]
    v_mfma_f32_16x16x32_bf16 v[20:23], a[36:39], a[12:15], v[20:23]
    v_mfma_f32_16x16x32_bf16 v[28:31], a[40:43], a[12:15], v[28:31]
    v_mfma_f32_16x16x32_bf16 v[36:39], a[44:47], a[12:15], v[36:39]
    s_waitcnt vmcnt(0)
L_phiq:
    v_pk_fma_f32 v[108:109], v[8:9], s[70:71], v[2:3]
    s_nop 2
    v_pk_fma_f32 v[84:85], v[12:13], s[70:71], v[2:3]
    v_pk_fma_f32 v[110:111], v[10:11], s[70:71], v[2:3]
    v_pk_fma_f32 v[86:87], v[14:15], s[70:71], v[2:3]
    v_exp_f32_e64 v108, v108 clamp
    v_exp_f32_e64 v84, v84 clamp
    v_exp_f32_e64 v109, v109 clamp
    v_exp_f32_e64 v85, v85 clamp
    v_exp_f32_e64 v110, v110 clamp
    v_exp_f32_e64 v86, v86 clamp
    v_exp_f32_e64 v111, v111 clamp
    v_exp_f32_e64 v87, v87 clamp
    v_max_f32 v8, s72, v8
    v_max_f32 v12, s72, v12
    v_max_f32 v9, s72, v9
    v_max_f32 v13, s72, v13
    v_max_f32 v10, s72, v10
    v_max_f32 v14, s72, v14
    v_max_f32 v11, s72, v11
    v_max_f32 v15, s72, v15
    v_pk_add_f32 v[8:9], v[8:9], v[108:109]
    v_pk_add_f32 v[12:13], v[12:13], v[84:85]
    v_pk_add_f32 v[10:11], v[10:11], v[110:111]
    v_pk_add_f32 v[14:15], v[14:15], v[86:87]
    v_cvt_pk_bf16_f32 v144, v8, v9
    v_cvt_pk_bf16_f32 v146, v12, v13
    v_cvt_pk_bf16_f32 v145, v10, v11
    v_cvt_pk_bf16_f32 v147, v14, v15
    v_pk_fma_f32 v[108:109], v[16:17], s[70:71], v[2:3]
    v_pk_fma_f32 v[84:85], v[20:21], s[70:71], v[2:3]
    v_pk_fma_f32 v[110:111], v[18:19], s[70:71], v[2:3]
    v_pk_fma_f32 v[86:87], v[22:23], s[70:71], v[2:3]
    v_exp_f32_e64 v108, v108 clamp
    v_exp_f32_e64 v84, v84 clamp
    v_exp_f32_e64 v109, v109 clamp
    v_exp_f32_e64 v85, v85 clamp
    v_exp_f32_e64 v110, v110 clamp
    v_exp_f32_e64 v86, v86 clamp
    v_exp_f32_e64 v111, v111 clamp
    v_exp_f32_e64 v87, v87 clamp
    v_max_f32 v16, s72, v16
    v_max_f32 v20, s72, v20
    v_max_f32 v17, s72, v17
    v_max_f32 v21, s72, v21
    v_max_f32 v18, s72, v18
    v_max_f32 v22, s72, v22
    v_max_f32 v19, s72, v19
    v_max_f32 v23, s72, v23
    v_pk_add_f32 v[16:17], v[16:17], v[108:109]
    v_pk_add_f32 v[20:21], v[20:21], v[84:85]
    v_pk_add_f32 v[18:19], v[18:19], v[110:111]
    v_pk_add_f32 v[22:23], v[22:23], v[86:87]
    v_cvt_pk_bf16_f32 v148, v16, v17
    v_cvt_pk_bf16_f32 v150, v20, v21
    v_cvt_pk_bf16_f32 v149, v18, v19
    v_cvt_pk_bf16_f32 v151, v22, v23
    v_pk_fma_f32 v[108:109], v[24:25], s[70:71], v[2:3]
    v_pk_fma_f32 v[84:85], v[28:29], s[70:71], v[2:3]
    v_pk_fma_f32 v[110:111], v[26:27], s[70:71], v[2:3]
    v_pk_fma_f32 v[86:87], v[30:31], s[70:71], v[2:3]
    v_exp_f32_e64 v108, v108 clamp
    v_exp_f32_e64 v84, v84 clamp
    v_exp_f32_e64 v109, v109 clamp
    v_exp_f32_e64 v85, v85 clamp
    v_exp_f32_e64 v110, v110 clamp
    v_exp_f32_e64 v86, v86 clamp
    v_exp_f32_e64 v111, v111 clamp
    v_exp_f32_e64 v87, v87 clamp
    v_max_f32 v24, s72, v24
    v_max_f32 v28, s72, v28
    v_max_f32 v25, s72, v25
    v_max_f32 v29, s72, v29
    v_max_f32 v26, s72, v26
    v_max_f32 v30, s72, v30
    v_max_f32 v27, s72, v27
    v_max_f32 v31, s72, v31
    v_pk_add_f32 v[24:25], v[24:25], v[108:109]
    v_pk_add_f32 v[28:29], v[28:29], v[84:85]
    v_pk_add_f32 v[26:27], v[26:27], v[110:111]
    v_pk_add_f32 v[30:31], v[30:31], v[86:87]
    v_cvt_pk_bf16_f32 v152, v24, v25
    v_cvt_pk_bf16_f32 v154, v28, v29
    v_cvt_pk_bf16_f32 v153, v26, v27
    v_cvt_pk_bf16_f32 v155, v30, v31
    v_pk_fma_f32 v[108:109], v[32:33], s[70:71], v[2:3]
    v_pk_fma_f32 v[84:85], v[36:37], s[70:71], v[2:3]
    v_pk_fma_f32 v[110:111], v[34:35], s[70:71], v[2:3]
    v_pk_fma_f32 v[86:87], v[38:39], s[70:71], v[2:3]
    v_exp_f32_e64 v108, v108 clamp
    v_exp_f32_e64 v84, v84 clamp
    v_exp_f32_e64 v109, v109 clamp
    v_exp_f32_e64 v85, v85 clamp
    v_exp_f32_e64 v110, v110 clamp
    v_exp_f32_e64 v86, v86 clamp
    v_exp_f32_e64 v111, v111 clamp
    v_exp_f32_e64 v87, v87 clamp
    v_max_f32 v32, s72, v32
    v_max_f32 v36, s72, v36
    v_max_f32 v33, s72, v33
    v_max_f32 v37, s72, v37
    v_max_f32 v34, s72, v34
    v_max_f32 v38, s72, v38
    v_max_f32 v35, s72, v35
    v_max_f32 v39, s72, v39
    v_pk_add_f32 v[32:33], v[32:33], v[108:109]
    v_pk_add_f32 v[36:37], v[36:37], v[84:85]
    v_pk_add_f32 v[34:35], v[34:35], v[110:111]
    v_pk_add_f32 v[38:39], v[38:39], v[86:87]
    v_cvt_pk_bf16_f32 v156, v32, v33
    v_cvt_pk_bf16_f32 v158, v36, v37
    v_cvt_pk_bf16_f32 v157, v34, v35
    v_cvt_pk_bf16_f32 v159, v38, v39
    v_lshrrev_b32 v5, 4, v0
    v_lshlrev_b32 v5, 4, v5
    v_lshlrev_b32 v6, 2, v0
    v_and_b32 v1, 15, v0
    v_lshrrev_b32 v2, 4, v0
    v_and_b32 v3, 1, v2
    v_lshlrev_b32 v3, 14, v3
    v_lshrrev_b32 v4, 1, v2
    v_lshl_add_u32 v3, v4, 9, v3
    v_lshl_add_u32 v3, v1, 4, v3
    s_lshl_b32 s52, s45, 17
    s_lshl_b32 s53, s47, 15
    s_add_u32 s52, s52, s53
    s_lshl_b32 s53, s46, 11
    s_add_u32 s52, s52, s53
    s_add_u32 s52, s52, 0x100000
    v_add_u32 v7, s52, v3
    s_mov_b32 s72, 0x358637bd
    s_barrier
L_ocalc:
    ds_read_b32 v40, v6 offset:0
    ds_read_b32 v41, v6 offset:256
    ds_read_b32 v42, v6 offset:512
    ds_read_b32 v43, v6 offset:768
    ds_read_b128 v[44:47], v5 offset:4096
    ds_read_b32 v48, v6 offset:1024
    ds_read_b32 v49, v6 offset:1280
    ds_read_b32 v50, v6 offset:1536
    ds_read_b32 v51, v6 offset:1792
    ds_read_b128 v[52:55], v5 offset:4160
    ds_read_b32 v56, v6 offset:2048
    ds_read_b32 v57, v6 offset:2304
    ds_read_b32 v58, v6 offset:2560
    ds_read_b32 v59, v6 offset:2816
    ds_read_b128 v[60:63], v5 offset:4224
    ds_read_b32 v64, v6 offset:3072
    ds_read_b32 v65, v6 offset:3328
    ds_read_b32 v66, v6 offset:3584
    ds_read_b32 v67, v6 offset:3840
    ds_read_b128 v[68:71], v5 offset:4288
    s_waitcnt lgkmcnt(15)
    v_cvt_pk_bf16_f32 v8, v40, v41
    v_cvt_pk_bf16_f32 v9, v42, v43
    v_cvt_pk_bf16_f32 v10, v44, v45
    v_cvt_pk_bf16_f32 v11, v46, v47
    s_waitcnt lgkmcnt(10)
    v_cvt_pk_bf16_f32 v12, v48, v49
    v_cvt_pk_bf16_f32 v13, v50, v51
    v_cvt_pk_bf16_f32 v14, v52, v53
    v_cvt_pk_bf16_f32 v15, v54, v55
    v_mfma_f32_16x16x16_bf16 v[80:83], v[10:11], v[144:145], 0
    v_mfma_f32_16x16x16_bf16 v[90:93], v[10:11], v[146:147], 0
    v_mfma_f32_16x16x16_bf16 v[100:103], v[14:15], v[148:149], 0
    v_mfma_f32_16x16x16_bf16 v[110:113], v[14:15], v[150:151], 0
    v_mfma_f32_16x16x16_bf16 v[76:79], v[8:9], v[144:145], 0
    v_mfma_f32_16x16x16_bf16 v[86:89], v[8:9], v[146:147], 0
    v_mfma_f32_16x16x16_bf16 v[96:99], v[12:13], v[148:149], 0
    v_mfma_f32_16x16x16_bf16 v[106:109], v[12:13], v[150:151], 0
    s_nop 0
    v_add_f32 v84, s72, v80
    v_add_f32 v94, s72, v90
    v_add_f32 v104, s72, v100
    v_add_f32 v114, s72, v110
    v_rcp_f32 v84, v84
    v_rcp_f32 v94, v94
    v_rcp_f32 v104, v104
    v_rcp_f32 v114, v114
    v_pk_mul_f32 v[76:77], v[76:77], v[84:85] op_sel_hi:[1,0]
    v_pk_mul_f32 v[86:87], v[86:87], v[94:95] op_sel_hi:[1,0]
    v_pk_mul_f32 v[96:97], v[96:97], v[104:105] op_sel_hi:[1,0]
    v_pk_mul_f32 v[106:107], v[106:107], v[114:115] op_sel_hi:[1,0]
    v_pk_mul_f32 v[78:79], v[78:79], v[84:85] op_sel_hi:[1,0]
    v_pk_mul_f32 v[88:89], v[88:89], v[94:95] op_sel_hi:[1,0]
    v_pk_mul_f32 v[98:99], v[98:99], v[104:105] op_sel_hi:[1,0]
    v_pk_mul_f32 v[108:109], v[108:109], v[114:115] op_sel_hi:[1,0]
    v_cvt_pk_bf16_f32 v144, v76, v77
    v_cvt_pk_bf16_f32 v146, v86, v87
    v_cvt_pk_bf16_f32 v148, v96, v97
    v_cvt_pk_bf16_f32 v150, v106, v107
    v_cvt_pk_bf16_f32 v145, v78, v79
    v_cvt_pk_bf16_f32 v147, v88, v89
    v_cvt_pk_bf16_f32 v149, v98, v99
    v_cvt_pk_bf16_f32 v151, v108, v109
    v_permlane16_swap_b32 v144, v146
    v_permlane16_swap_b32 v145, v147
    v_permlane16_swap_b32 v148, v150
    v_permlane16_swap_b32 v149, v151
    buffer_store_dwordx4 v[144:147], v7, s[36:39], 0 offen offset:0 sc1
    buffer_store_dwordx4 v[148:151], v7, s[36:39], 0 offen offset:256 sc1
    s_waitcnt lgkmcnt(5)
    v_cvt_pk_bf16_f32 v16, v56, v57
    v_cvt_pk_bf16_f32 v17, v58, v59
    v_cvt_pk_bf16_f32 v18, v60, v61
    v_cvt_pk_bf16_f32 v19, v62, v63
    s_waitcnt lgkmcnt(0)
    v_cvt_pk_bf16_f32 v20, v64, v65
    v_cvt_pk_bf16_f32 v21, v66, v67
    v_cvt_pk_bf16_f32 v22, v68, v69
    v_cvt_pk_bf16_f32 v23, v70, v71
    v_mfma_f32_16x16x16_bf16 v[80:83], v[18:19], v[152:153], 0
    v_mfma_f32_16x16x16_bf16 v[90:93], v[18:19], v[154:155], 0
    v_mfma_f32_16x16x16_bf16 v[100:103], v[22:23], v[156:157], 0
    v_mfma_f32_16x16x16_bf16 v[110:113], v[22:23], v[158:159], 0
    v_mfma_f32_16x16x16_bf16 v[76:79], v[16:17], v[152:153], 0
    v_mfma_f32_16x16x16_bf16 v[86:89], v[16:17], v[154:155], 0
    v_mfma_f32_16x16x16_bf16 v[96:99], v[20:21], v[156:157], 0
    v_mfma_f32_16x16x16_bf16 v[106:109], v[20:21], v[158:159], 0
    s_nop 0
    v_add_f32 v84, s72, v80
    v_add_f32 v94, s72, v90
    v_add_f32 v104, s72, v100
    v_add_f32 v114, s72, v110
    v_rcp_f32 v84, v84
    v_rcp_f32 v94, v94
    v_rcp_f32 v104, v104
    v_rcp_f32 v114, v114
    v_pk_mul_f32 v[76:77], v[76:77], v[84:85] op_sel_hi:[1,0]
    v_pk_mul_f32 v[86:87], v[86:87], v[94:95] op_sel_hi:[1,0]
    v_pk_mul_f32 v[96:97], v[96:97], v[104:105] op_sel_hi:[1,0]
    v_pk_mul_f32 v[106:107], v[106:107], v[114:115] op_sel_hi:[1,0]
    v_pk_mul_f32 v[78:79], v[78:79], v[84:85] op_sel_hi:[1,0]
    v_pk_mul_f32 v[88:89], v[88:89], v[94:95] op_sel_hi:[1,0]
    v_pk_mul_f32 v[98:99], v[98:99], v[104:105] op_sel_hi:[1,0]
    v_pk_mul_f32 v[108:109], v[108:109], v[114:115] op_sel_hi:[1,0]
    v_cvt_pk_bf16_f32 v152, v76, v77
    v_cvt_pk_bf16_f32 v154, v86, v87
    v_cvt_pk_bf16_f32 v156, v96, v97
    v_cvt_pk_bf16_f32 v158, v106, v107
    v_cvt_pk_bf16_f32 v153, v78, v79
    v_cvt_pk_bf16_f32 v155, v88, v89
    v_cvt_pk_bf16_f32 v157, v98, v99
    v_cvt_pk_bf16_f32 v159, v108, v109
    v_permlane16_swap_b32 v152, v154
    v_permlane16_swap_b32 v153, v155
    v_permlane16_swap_b32 v156, v158
    v_permlane16_swap_b32 v157, v159
    buffer_store_dwordx4 v[152:155], v7, s[36:39], 0 offen offset:1024 sc1
    buffer_store_dwordx4 v[156:159], v7, s[36:39], 0 offen offset:1280 sc1
    s_branch L_p2wait
L_mainB:
    v_and_b32 v3, 1, v2
    v_lshlrev_b32 v3, 14, v3
    v_lshrrev_b32 v4, 1, v2
    v_lshl_add_u32 v3, v4, 9, v3
    v_lshl_add_u32 v3, v1, 4, v3
    s_lshl_b32 s52, s45, 17
    s_lshl_b32 s53, s46, 11
    s_add_u32 s52, s52, s53
    s_lshr_b32 s53, s47, 1
    s_lshl_b32 s53, s53, 10
    s_add_u32 s52, s52, s53
    s_and_b32 s53, s47, 1
    s_lshl_b32 s53, s53, 8
    s_add_u32 s52, s52, s53
    s_lshl_b32 s53, s44, 21
    s_add_u32 s52, s52, s53
    s_add_u32 s52, s52, 0x100000
    v_add_u32 v7, s52, v3
    v_lshlrev_b32 v3, 2, v2
    v_mov_b32 v6, 0xf149f2ca
    v_add_u32 v4, 0, v3
    v_sub_u32 v5, v1, v4
    v_cmp_gt_u32 vcc, 8, v5
    s_nop 1
    v_cndmask_b32_e64 v122, v6, 0, vcc
    v_cndmask_b32_e64 v138, 0, -1, vcc
    v_and_b32 v138, 0xffff, v138
    v_sub_u32 v5, v4, v1
    v_cmp_le_i32 vcc, 9, v5
    s_nop 1
    v_cndmask_b32_e64 v126, v6, 0, vcc
    v_cmp_le_i32 vcc, 1, v5
    s_nop 1
    v_cndmask_b32_e64 v130, v6, 0, vcc
    v_cmp_ge_u32 vcc, 7, v4
    s_nop 1
    v_cndmask_b32_e64 v130, v6, v130, vcc
    v_mov_b32 v134, v126
    v_add_u32 v4, 1, v3
    v_sub_u32 v5, v1, v4
    v_cmp_gt_u32 vcc, 8, v5
    s_nop 1
    v_cndmask_b32_e64 v123, v6, 0, vcc
    v_cndmask_b32_e64 v5, 0, -1, vcc
    v_and_b32 v5, 0xffff0000, v5
    v_or_b32 v138, v138, v5
    v_sub_u32 v5, v4, v1
    v_cmp_le_i32 vcc, 9, v5
    s_nop 1
    v_cndmask_b32_e64 v127, v6, 0, vcc
    v_cmp_le_i32 vcc, 1, v5
    s_nop 1
    v_cndmask_b32_e64 v131, v6, 0, vcc
    v_cmp_ge_u32 vcc, 7, v4
    s_nop 1
    v_cndmask_b32_e64 v131, v6, v131, vcc
    v_mov_b32 v135, v127
    v_add_u32 v4, 2, v3
    v_sub_u32 v5, v1, v4
    v_cmp_gt_u32 vcc, 8, v5
    s_nop 1
    v_cndmask_b32_e64 v124, v6, 0, vcc
    v_cndmask_b32_e64 v139, 0, -1, vcc
    v_and_b32 v139, 0xffff, v139
    v_sub_u32 v5, v4, v1
    v_cmp_le_i32 vcc, 9, v5
    s_nop 1
    v_cndmask_b32_e64 v128, v6, 0, vcc
    v_cmp_le_i32 vcc, 1, v5
    s_nop 1
    v_cndmask_b32_e64 v132, v6, 0, vcc
    v_cmp_ge_u32 vcc, 7, v4
    s_nop 1
    v_cndmask_b32_e64 v132, v6, v132, vcc
    v_mov_b32 v136, v128
    v_add_u32 v4, 3, v3
    v_sub_u32 v5, v1, v4
    v_cmp_gt_u32 vcc, 8, v5
    s_nop 1
    v_cndmask_b32_e64 v125, v6, 0, vcc
    v_cndmask_b32_e64 v5, 0, -1, vcc
    v_and_b32 v5, 0xffff0000, v5
    v_or_b32 v139, v139, v5
    v_sub_u32 v5, v4, v1
    v_cmp_le_i32 vcc, 9, v5
    s_nop 1
    v_cndmask_b32_e64 v129, v6, 0, vcc
    v_cmp_le_i32 vcc, 1, v5
    s_nop 1
    v_cndmask_b32_e64 v133, v6, 0, vcc
    v_cmp_ge_u32 vcc, 7, v4
    s_nop 1
    v_cndmask_b32_e64 v133, v6, v133, vcc
    v_mov_b32 v137, v129
    s_cmp_eq_u32 s45, 0
    s_cbranch_scc0 L_nomask
    v_mov_b32 v130, v6
    v_mov_b32 v134, v6
    v_mov_b32 v131, v6
    v_mov_b32 v135, v6
    v_mov_b32 v132, v6
    v_mov_b32 v136, v6
    v_mov_b32 v133, v6
    v_mov_b32 v137, v6
L_nomask:
    s_mov_b32 s70, 0x3eb8aa3b
    s_mov_b32 s71, 0x3eb8aa3b
    s_barrier
    ds_read_b64_tr_b16 a[36:37], v118 offset:0
    ds_read_b64_tr_b16 a[38:39], v118 offset:512
    ds_read_b64_tr_b16 a[40:41], v118 offset:8192
    ds_read_b64_tr_b16 a[42:43], v118 offset:8704
    ds_read_b64_tr_b16 a[44:45], v118 offset:16384
    ds_read_b64_tr_b16 a[46:47], v118 offset:16896
    ds_read_b128 a[0:3], v112 offset:0
    ds_read_b128 a[4:7], v112 offset:2048
    ds_read_b128 a[8:11], v112 offset:4096
    ds_read_b128 a[12:15], v112 offset:6144
    ds_read_b128 a[16:19], v112 offset:8192
    ds_read_b128 a[20:23], v112 offset:10240
    ds_read_b128 a[24:27], v112 offset:12288
    ds_read_b128 a[28:31], v112 offset:14336
    ds_read_b128 a[32:35], v112 offset:16384
    s_waitcnt lgkmcnt(8)
    v_mfma_f32_16x16x32_bf16 v[8:11], a[36:39], a[0:3], 0
    ds_read_b64_tr_b16 a[48:49], v118 offset:4096
    v_mfma_f32_16x16x32_bf16 v[40:43], a[40:43], a[0:3], 0
    ds_read_b64_tr_b16 a[50:51], v118 offset:4608
    v_mfma_f32_16x16x32_bf16 v[76:79], a[0:3], a[44:47], 0
    ds_read_b128 a[0:3], v113 offset:0
    s_waitcnt lgkmcnt(10)
    v_mfma_f32_16x16x32_bf16 v[12:15], a[36:39], a[4:7], 0
    ds_read_b64_tr_b16 a[52:53], v118 offset:12288
    v_mfma_f32_16x16x32_bf16 v[44:47], a[40:43], a[4:7], 0
    ds_read_b64_tr_b16 a[54:55], v118 offset:12800
    v_mfma_f32_16x16x32_bf16 v[80:83], a[4:7], a[44:47], 0
    ds_read_b128 a[4:7], v113 offset:2048
    s_waitcnt lgkmcnt(12)
    v_mfma_f32_16x16x32_bf16 v[16:19], a[36:39], a[8:11], 0
    ds_read_b64_tr_b16 a[56:57], v118 offset:20480
    v_mfma_f32_16x16x32_bf16 v[48:51], a[40:43], a[8:11], 0
    ds_read_b64_tr_b16 a[58:59], v118 offset:20992
    v_mfma_f32_16x16x32_bf16 v[84:87], a[8:11], a[44:47], 0
    ds_read_b128 a[8:11], v113 offset:4096
    s_waitcnt lgkmcnt(14)
    v_mfma_f32_16x16x32_bf16 v[20:23], a[36:39], a[12:15], 0
    v_mfma_f32_16x16x32_bf16 v[52:55], a[40:43], a[12:15], 0
    v_mfma_f32_16x16x32_bf16 v[88:91], a[12:15], a[44:47], 0
    ds_read_b128 a[12:15], v113 offset:6144
    s_waitcnt lgkmcnt(14)
    v_mfma_f32_16x16x32_bf16 v[24:27], a[36:39], a[16:19], 0
    v_mfma_f32_16x16x32_bf16 v[56:59], a[40:43], a[16:19], 0
    v_mfma_f32_16x16x32_bf16 v[92:95], a[16:19], a[44:47], 0
    ds_read_b128 a[16:19], v113 offset:8192
    s_waitcnt lgkmcnt(14)
    v_mfma_f32_16x16x32_bf16 v[28:31], a[36:39], a[20:23], 0
    v_mfma_f32_16x16x32_bf16 v[60:63], a[40:43], a[20:23], 0
    v_mfma_f32_16x16x32_bf16 v[96:99], a[20:23], a[44:47], 0
    ds_read_b128 a[20:23], v113 offset:10240
    s_waitcnt lgkmcnt(14)
    v_mfma_f32_16x16x32_bf16 v[32:35], a[36:39], a[24:27], 0
    v_mfma_f32_16x16x32_bf16 v[64:67], a[40:43], a[24:27], 0
    v_mfma_f32_16x16x32_bf16 v[100:103], a[24:27], a[44:47], 0
    ds_read_b128 a[24:27], v113 offset:12288
    s_waitcnt lgkmcnt(14)
    v_mfma_f32_16x16x32_bf16 v[36:39], a[36:39], a[28:31], 0
    v_mfma_f32_16x16x32_bf16 v[68:71], a[40:43], a[28:31], 0
    v_mfma_f32_16x16x32_bf16 v[104:107], a[28:31], a[44:47], 0
    ds_read_b128 a[28:31], v113 offset:14336
    s_waitcnt lgkmcnt(14)
    v_mfma_f32_16x16x32_bf16 v[72:75], a[40:43], a[32:35], 0
    v_mfma_f32_16x16x32_bf16 v[108:111], a[32:35], a[44:47], 0
    ds_read_b128 a[32:35], v113 offset:16384
    s_waitcnt lgkmcnt(7)
    v_mfma_f32_16x16x32_bf16 v[8:11], a[48:51], a[0:3], v[8:11]
    v_mfma_f32_16x16x32_bf16 v[40:43], a[52:55], a[0:3], v[40:43]
    v_mfma_f32_16x16x32_bf16 v[76:79], a[0:3], a[56:59], v[76:79]
    v_mfma_f32_16x16x32_bf16 v[12:15], a[48:51], a[4:7], v[12:15]
    v_mfma_f32_16x16x32_bf16 v[44:47], a[52:55], a[4:7], v[44:47]
    v_mfma_f32_16x16x32_bf16 v[80:83], a[4:7], a[56:59], v[80:83]
    s_waitcnt lgkmcnt(6)
    v_mfma_f32_16x16x32_bf16 v[16:19], a[48:51], a[8:11], v[16:19]
    v_mfma_f32_16x16x32_bf16 v[48:51], a[52:55], a[8:11], v[48:51]
    v_mfma_f32_16x16x32_bf16 v[84:87], a[8:11], a[56:59], v[84:87]
    s_waitcnt lgkmcnt(0)
    s_barrier
    ds_read_b64_tr_b16 a[36:37], v119 offset:0
    ds_read_b64_tr_b16 a[38:39], v119 offset:512
    v_mfma_f32_16x16x32_bf16 v[20:23], a[48:51], a[12:15], v[20:23]
    ds_read_b64_tr_b16 a[40:41], v119 offset:8192
    v_mfma_f32_16x16x32_bf16 v[52:55], a[52:55], a[12:15], v[52:55]
    ds_read_b64_tr_b16 a[42:43], v119 offset:8704
    v_mfma_f32_16x16x32_bf16 v[88:91], a[12:15], a[56:59], v[88:91]
    ds_read_b64_tr_b16 a[44:45], v119 offset:16384
    v_mfma_f32_16x16x32_bf16 v[24:27], a[48:51], a[16:19], v[24:27]
    ds_read_b64_tr_b16 a[46:47], v119 offset:16896
    v_mfma_f32_16x16x32_bf16 v[56:59], a[52:55], a[16:19], v[56:59]
    ds_read_b128 a[0:3], v114 offset:0
    v_mfma_f32_16x16x32_bf16 v[92:95], a[16:19], a[56:59], v[92:95]
    ds_read_b128 a[4:7], v114 offset:2048
    v_mfma_f32_16x16x32_bf16 v[28:31], a[48:51], a[20:23], v[28:31]
    ds_read_b128 a[8:11], v114 offset:4096
    v_mfma_f32_16x16x32_bf16 v[60:63], a[52:55], a[20:23], v[60:63]
    ds_read_b128 a[12:15], v114 offset:6144
    v_mfma_f32_16x16x32_bf16 v[96:99], a[20:23], a[56:59], v[96:99]
    ds_read_b128 a[16:19], v114 offset:8192
    v_mfma_f32_16x16x32_bf16 v[32:35], a[48:51], a[24:27], v[32:35]
    ds_read_b128 a[20:23], v114 offset:10240
    v_mfma_f32_16x16x32_bf16 v[64:67], a[52:55], a[24:27], v[64:67]
    v_mfma_f32_16x16x32_bf16 v[100:103], a[24:27], a[56:59], v[100:103]
    ds_read_b128 a[24:27], v114 offset:12288
    v_mfma_f32_16x16x32_bf16 v[36:39], a[48:51], a[28:31], v[36:39]
    v_mfma_f32_16x16x32_bf16 v[68:71], a[52:55], a[28:31], v[68:71]
    v_mfma_f32_16x16x32_bf16 v[104:107], a[28:31], a[56:59], v[104:107]
    ds_read_b128 a[28:31], v114 offset:14336
    v_mfma_f32_16x16x32_bf16 v[72:75], a[52:55], a[32:35], v[72:75]
    v_mfma_f32_16x16x32_bf16 v[108:111], a[32:35], a[56:59], v[108:111]
    ds_read_b128 a[32:35], v114 offset:16384
    s_waitcnt lgkmcnt(8)
    v_mfma_f32_16x16x32_bf16 v[8:11], a[36:39], a[0:3], v[8:11]
    ds_read_b64_tr_b16 a[48:49], v119 offset:4096
    v_mfma_f32_16x16x32_bf16 v[40:43], a[40:43], a[0:3], v[40:43]
    ds_read_b64_tr_b16 a[50:51], v119 offset:4608
    v_mfma_f32_16x16x32_bf16 v[76:79], a[0:3], a[44:47], v[76:79]
    ds_read_b128 a[0:3], v115 offset:0
    s_waitcnt lgkmcnt(10)
    v_mfma_f32_16x16x32_bf16 v[12:15], a[36:39], a[4:7], v[12:15]
    ds_read_b64_tr_b16 a[52:53], v119 offset:12288
    v_mfma_f32_16x16x32_bf16 v[44:47], a[40:43], a[4:7], v[44:47]
    ds_read_b64_tr_b16 a[54:55], v119 offset:12800
    v_mfma_f32_16x16x32_bf16 v[80:83], a[4:7], a[44:47], v[80:83]
    ds_read_b128 a[4:7], v115 offset:2048
    s_waitcnt lgkmcnt(12)
    v_mfma_f32_16x16x32_bf16 v[16:19], a[36:39], a[8:11], v[16:19]
    ds_read_b64_tr_b16 a[56:57], v119 offset:20480
    v_mfma_f32_16x16x32_bf16 v[48:51], a[40:43], a[8:11], v[48:51]
    ds_read_b64_tr_b16 a[58:59], v119 offset:20992
    v_mfma_f32_16x16x32_bf16 v[84:87], a[8:11], a[44:47], v[84:87]
    ds_read_b128 a[8:11], v115 offset:4096
    s_waitcnt lgkmcnt(14)
    v_mfma_f32_16x16x32_bf16 v[20:23], a[36:39], a[12:15], v[20:23]
    v_mfma_f32_16x16x32_bf16 v[52:55], a[40:43], a[12:15], v[52:55]
    v_mfma_f32_16x16x32_bf16 v[88:91], a[12:15], a[44:47], v[88:91]
    ds_read_b128 a[12:15], v115 offset:6144
    s_waitcnt lgkmcnt(14)
    v_mfma_f32_16x16x32_bf16 v[24:27], a[36:39], a[16:19], v[24:27]
    v_mfma_f32_16x16x32_bf16 v[56:59], a[40:43], a[16:19], v[56:59]
    v_mfma_f32_16x16x32_bf16 v[92:95], a[16:19], a[44:47], v[92:95]
    ds_read_b128 a[16:19], v115 offset:8192
    s_waitcnt lgkmcnt(14)
    v_mfma_f32_16x16x32_bf16 v[28:31], a[36:39], a[20:23], v[28:31]
    v_mfma_f32_16x16x32_bf16 v[60:63], a[40:43], a[20:23], v[60:63]
    v_mfma_f32_16x16x32_bf16 v[96:99], a[20:23], a[44:47], v[96:99]
    ds_read_b128 a[20:23], v115 offset:10240
    s_waitcnt lgkmcnt(14)
    v_mfma_f32_16x16x32_bf16 v[32:35], a[36:39], a[24:27], v[32:35]
    v_mfma_f32_16x16x32_bf16 v[64:67], a[40:43], a[24:27], v[64:67]
    v_mfma_f32_16x16x32_bf16 v[100:103], a[24:27], a[44:47], v[100:103]
    ds_read_b128 a[24:27], v115 offset:12288
    s_waitcnt lgkmcnt(14)
    v_mfma_f32_16x16x32_bf16 v[36:39], a[36:39], a[28:31], v[36:39]
    v_mfma_f32_16x16x32_bf16 v[68:71], a[40:43], a[28:31], v[68:71]
    v_mfma_f32_16x16x32_bf16 v[104:107], a[28:31], a[44:47], v[104:107]
    ds_read_b128 a[28:31], v115 offset:14336
    s_waitcnt lgkmcnt(14)
    v_mfma_f32_16x16x32_bf16 v[72:75], a[40:43], a[32:35], v[72:75]
    v_mfma_f32_16x16x32_bf16 v[108:111], a[32:35], a[44:47], v[108:111]
    ds_read_b128 a[32:35], v115 offset:16384
    s_waitcnt lgkmcnt(7)
    v_mfma_f32_16x16x32_bf16 v[8:11], a[48:51], a[0:3], v[8:11]
    v_mfma_f32_16x16x32_bf16 v[40:43], a[52:55], a[0:3], v[40:43]
    v_mfma_f32_16x16x32_bf16 v[76:79], a[0:3], a[56:59], v[76:79]
    v_mfma_f32_16x16x32_bf16 v[12:15], a[48:51], a[4:7], v[12:15]
    v_mfma_f32_16x16x32_bf16 v[44:47], a[52:55], a[4:7], v[44:47]
    v_mfma_f32_16x16x32_bf16 v[80:83], a[4:7], a[56:59], v[80:83]
    s_waitcnt lgkmcnt(6)
    v_mfma_f32_16x16x32_bf16 v[16:19], a[48:51], a[8:11], v[16:19]
    v_mfma_f32_16x16x32_bf16 v[48:51], a[52:55], a[8:11], v[48:51]
    v_mfma_f32_16x16x32_bf16 v[84:87], a[8:11], a[56:59], v[84:87]
    s_waitcnt lgkmcnt(0)
    s_barrier
    s_cmp_ge_u32 s47, 2
    s_cbranch_scc1 L_wot_2
    s_lshr_b32 s52, s2, 3
    s_lshl_b32 s52, s52, 14
    s_lshl_b32 s53, s47, 13
    s_add_u32 s52, s52, s53
    v_lshlrev_b32 v154, 7, v0
    v_add_u32 v154, s52, v154
    buffer_load_dword v155, v154, s[28:31], 0 offen
L_wot_2:
    ds_read_b64_tr_b16 a[36:37], v120 offset:0
    ds_read_b64_tr_b16 a[38:39], v120 offset:512
    v_mfma_f32_16x16x32_bf16 v[20:23], a[48:51], a[12:15], v[20:23]
    ds_read_b64_tr_b16 a[40:41], v120 offset:8192
    v_mfma_f32_16x16x32_bf16 v[52:55], a[52:55], a[12:15], v[52:55]
    ds_read_b64_tr_b16 a[42:43], v120 offset:8704
    v_mfma_f32_16x16x32_bf16 v[88:91], a[12:15], a[56:59], v[88:91]
    ds_read_b64_tr_b16 a[44:45], v120 offset:16384
    v_mfma_f32_16x16x32_bf16 v[24:27], a[48:51], a[16:19], v[24:27]
    ds_read_b64_tr_b16 a[46:47], v120 offset:16896
    v_mfma_f32_16x16x32_bf16 v[56:59], a[52:55], a[16:19], v[56:59]
    ds_read_b128 a[0:3], v116 offset:0
    v_mfma_f32_16x16x32_bf16 v[92:95], a[16:19], a[56:59], v[92:95]
    ds_read_b128 a[4:7], v116 offset:2048
    v_mfma_f32_16x16x32_bf16 v[28:31], a[48:51], a[20:23], v[28:31]
    ds_read_b128 a[8:11], v116 offset:4096
    v_mfma_f32_16x16x32_bf16 v[60:63], a[52:55], a[20:23], v[60:63]
    ds_read_b128 a[12:15], v116 offset:6144
    v_mfma_f32_16x16x32_bf16 v[96:99], a[20:23], a[56:59], v[96:99]
    ds_read_b128 a[16:19], v116 offset:8192
    v_mfma_f32_16x16x32_bf16 v[32:35], a[48:51], a[24:27], v[32:35]
    ds_read_b128 a[20:23], v116 offset:10240
    v_mfma_f32_16x16x32_bf16 v[64:67], a[52:55], a[24:27], v[64:67]
    v_mfma_f32_16x16x32_bf16 v[100:103], a[24:27], a[56:59], v[100:103]
    ds_read_b128 a[24:27], v116 offset:12288
    v_mfma_f32_16x16x32_bf16 v[36:39], a[48:51], a[28:31], v[36:39]
    v_mfma_f32_16x16x32_bf16 v[68:71], a[52:55], a[28:31], v[68:71]
    v_mfma_f32_16x16x32_bf16 v[104:107], a[28:31], a[56:59], v[104:107]
    ds_read_b128 a[28:31], v116 offset:14336
    v_mfma_f32_16x16x32_bf16 v[72:75], a[52:55], a[32:35], v[72:75]
    v_mfma_f32_16x16x32_bf16 v[108:111], a[32:35], a[56:59], v[108:111]
    ds_read_b128 a[32:35], v116 offset:16384
    s_waitcnt lgkmcnt(8)
    v_mfma_f32_16x16x32_bf16 v[8:11], a[36:39], a[0:3], v[8:11]
    ds_read_b64_tr_b16 a[48:49], v120 offset:4096
    v_mfma_f32_16x16x32_bf16 v[40:43], a[40:43], a[0:3], v[40:43]
    ds_read_b64_tr_b16 a[50:51], v120 offset:4608
    v_mfma_f32_16x16x32_bf16 v[76:79], a[0:3], a[44:47], v[76:79]
    ds_read_b128 a[0:3], v117 offset:0
    s_waitcnt lgkmcnt(10)
    v_mfma_f32_16x16x32_bf16 v[12:15], a[36:39], a[4:7], v[12:15]
    ds_read_b64_tr_b16 a[52:53], v120 offset:12288
    v_mfma_f32_16x16x32_bf16 v[44:47], a[40:43], a[4:7], v[44:47]
    ds_read_b64_tr_b16 a[54:55], v120 offset:12800
    v_mfma_f32_16x16x32_bf16 v[80:83], a[4:7], a[44:47], v[80:83]
    ds_read_b128 a[4:7], v117 offset:2048
    s_waitcnt lgkmcnt(12)
    v_mfma_f32_16x16x32_bf16 v[16:19], a[36:39], a[8:11], v[16:19]
    ds_read_b64_tr_b16 a[56:57], v120 offset:20480
    v_mfma_f32_16x16x32_bf16 v[48:51], a[40:43], a[8:11], v[48:51]
    ds_read_b64_tr_b16 a[58:59], v120 offset:20992
    v_mfma_f32_16x16x32_bf16 v[84:87], a[8:11], a[44:47], v[84:87]
    ds_read_b128 a[8:11], v117 offset:4096
    s_waitcnt lgkmcnt(14)
    v_mfma_f32_16x16x32_bf16 v[20:23], a[36:39], a[12:15], v[20:23]
    v_mfma_f32_16x16x32_bf16 v[52:55], a[40:43], a[12:15], v[52:55]
    v_mfma_f32_16x16x32_bf16 v[88:91], a[12:15], a[44:47], v[88:91]
    ds_read_b128 a[12:15], v117 offset:6144
    s_waitcnt lgkmcnt(14)
    v_mfma_f32_16x16x32_bf16 v[24:27], a[36:39], a[16:19], v[24:27]
    v_mfma_f32_16x16x32_bf16 v[56:59], a[40:43], a[16:19], v[56:59]
    v_mfma_f32_16x16x32_bf16 v[92:95], a[16:19], a[44:47], v[92:95]
    ds_read_b128 a[16:19], v117 offset:8192
    s_waitcnt lgkmcnt(14)
    v_mfma_f32_16x16x32_bf16 v[28:31], a[36:39], a[20:23], v[28:31]
    v_mfma_f32_16x16x32_bf16 v[60:63], a[40:43], a[20:23], v[60:63]
    v_mfma_f32_16x16x32_bf16 v[96:99], a[20:23], a[44:47], v[96:99]
    ds_read_b128 a[20:23], v117 offset:10240
    s_waitcnt lgkmcnt(14)
    v_mfma_f32_16x16x32_bf16 v[32:35], a[36:39], a[24:27], v[32:35]
    v_mfma_f32_16x16x32_bf16 v[64:67], a[40:43], a[24:27], v[64:67]
    v_mfma_f32_16x16x32_bf16 v[100:103], a[24:27], a[44:47], v[100:103]
    ds_read_b128 a[24:27], v117 offset:12288
    s_waitcnt lgkmcnt(14)
    v_mfma_f32_16x16x32_bf16 v[36:39], a[36:39], a[28:31], v[36:39]
    v_mfma_f32_16x16x32_bf16 v[68:71], a[40:43], a[28:31], v[68:71]
    v_mfma_f32_16x16x32_bf16 v[104:107], a[28:31], a[44:47], v[104:107]
    ds_read_b128 a[28:31], v117 offset:14336
    s_waitcnt lgkmcnt(14)
    v_mfma_f32_16x16x32_bf16 v[72:75], a[40:43], a[32:35], v[72:75]
    v_mfma_f32_16x16x32_bf16 v[108:111], a[32:35], a[44:47], v[108:111]
    ds_read_b128 a[32:35], v117 offset:16384
    s_waitcnt lgkmcnt(7)
    v_mfma_f32_16x16x32_bf16 v[8:11], a[48:51], a[0:3], v[8:11]
    v_mfma_f32_16x16x32_bf16 v[40:43], a[52:55], a[0:3], v[40:43]
    v_mfma_f32_16x16x32_bf16 v[76:79], a[0:3], a[56:59], v[76:79]
    v_mfma_f32_16x16x32_bf16 v[12:15], a[48:51], a[4:7], v[12:15]
    v_mfma_f32_16x16x32_bf16 v[44:47], a[52:55], a[4:7], v[44:47]
    v_mfma_f32_16x16x32_bf16 v[80:83], a[4:7], a[56:59], v[80:83]
    s_waitcnt lgkmcnt(6)
    v_mfma_f32_16x16x32_bf16 v[16:19], a[48:51], a[8:11], v[16:19]
    v_mfma_f32_16x16x32_bf16 v[48:51], a[52:55], a[8:11], v[48:51]
    v_mfma_f32_16x16x32_bf16 v[84:87], a[8:11], a[56:59], v[84:87]
    s_waitcnt lgkmcnt(0)
    s_barrier
    ds_read_b64_tr_b16 a[36:37], v118 offset:0
    ds_read_b64_tr_b16 a[38:39], v118 offset:512
    v_mfma_f32_16x16x32_bf16 v[20:23], a[48:51], a[12:15], v[20:23]
    ds_read_b64_tr_b16 a[40:41], v118 offset:8192
    v_mfma_f32_16x16x32_bf16 v[52:55], a[52:55], a[12:15], v[52:55]
    ds_read_b64_tr_b16 a[42:43], v118 offset:8704
    v_mfma_f32_16x16x32_bf16 v[88:91], a[12:15], a[56:59], v[88:91]
    ds_read_b64_tr_b16 a[44:45], v118 offset:16384
    v_mfma_f32_16x16x32_bf16 v[24:27], a[48:51], a[16:19], v[24:27]
    ds_read_b64_tr_b16 a[46:47], v118 offset:16896
    v_mfma_f32_16x16x32_bf16 v[56:59], a[52:55], a[16:19], v[56:59]
    ds_read_b128 a[0:3], v112 offset:0
    v_mfma_f32_16x16x32_bf16 v[92:95], a[16:19], a[56:59], v[92:95]
    ds_read_b128 a[4:7], v112 offset:2048
    v_mfma_f32_16x16x32_bf16 v[28:31], a[48:51], a[20:23], v[28:31]
    ds_read_b128 a[8:11], v112 offset:4096
    v_mfma_f32_16x16x32_bf16 v[60:63], a[52:55], a[20:23], v[60:63]
    ds_read_b128 a[12:15], v112 offset:6144
    v_mfma_f32_16x16x32_bf16 v[96:99], a[20:23], a[56:59], v[96:99]
    ds_read_b128 a[16:19], v112 offset:8192
    v_mfma_f32_16x16x32_bf16 v[32:35], a[48:51], a[24:27], v[32:35]
    ds_read_b128 a[20:23], v112 offset:10240
    v_mfma_f32_16x16x32_bf16 v[64:67], a[52:55], a[24:27], v[64:67]
    v_mfma_f32_16x16x32_bf16 v[100:103], a[24:27], a[56:59], v[100:103]
    ds_read_b128 a[24:27], v112 offset:12288
    v_mfma_f32_16x16x32_bf16 v[36:39], a[48:51], a[28:31], v[36:39]
    v_mfma_f32_16x16x32_bf16 v[68:71], a[52:55], a[28:31], v[68:71]
    v_mfma_f32_16x16x32_bf16 v[104:107], a[28:31], a[56:59], v[104:107]
    ds_read_b128 a[28:31], v112 offset:14336
    v_mfma_f32_16x16x32_bf16 v[72:75], a[52:55], a[32:35], v[72:75]
    v_mfma_f32_16x16x32_bf16 v[108:111], a[32:35], a[56:59], v[108:111]
    ds_read_b128 a[32:35], v112 offset:16384
    s_waitcnt lgkmcnt(8)
    v_mfma_f32_16x16x32_bf16 v[8:11], a[36:39], a[0:3], v[8:11]
    ds_read_b64_tr_b16 a[48:49], v118 offset:4096
    v_mfma_f32_16x16x32_bf16 v[40:43], a[40:43], a[0:3], v[40:43]
    ds_read_b64_tr_b16 a[50:51], v118 offset:4608
    v_mfma_f32_16x16x32_bf16 v[76:79], a[0:3], a[44:47], v[76:79]
    ds_read_b128 a[0:3], v113 offset:0
    s_waitcnt lgkmcnt(10)
    v_mfma_f32_16x16x32_bf16 v[12:15], a[36:39], a[4:7], v[12:15]
    ds_read_b64_tr_b16 a[52:53], v118 offset:12288
    v_mfma_f32_16x16x32_bf16 v[44:47], a[40:43], a[4:7], v[44:47]
    ds_read_b64_tr_b16 a[54:55], v118 offset:12800
    v_mfma_f32_16x16x32_bf16 v[80:83], a[4:7], a[44:47], v[80:83]
    ds_read_b128 a[4:7], v113 offset:2048
    s_waitcnt lgkmcnt(12)
    v_mfma_f32_16x16x32_bf16 v[16:19], a[36:39], a[8:11], v[16:19]
    ds_read_b64_tr_b16 a[56:57], v118 offset:20480
    v_mfma_f32_16x16x32_bf16 v[48:51], a[40:43], a[8:11], v[48:51]
    ds_read_b64_tr_b16 a[58:59], v118 offset:20992
    v_mfma_f32_16x16x32_bf16 v[84:87], a[8:11], a[44:47], v[84:87]
    ds_read_b128 a[8:11], v113 offset:4096
    s_waitcnt lgkmcnt(14)
    v_mfma_f32_16x16x32_bf16 v[20:23], a[36:39], a[12:15], v[20:23]
    v_mfma_f32_16x16x32_bf16 v[52:55], a[40:43], a[12:15], v[52:55]
    v_mfma_f32_16x16x32_bf16 v[88:91], a[12:15], a[44:47], v[88:91]
    ds_read_b128 a[12:15], v113 offset:6144
    s_waitcnt lgkmcnt(14)
    v_mfma_f32_16x16x32_bf16 v[24:27], a[36:39], a[16:19], v[24:27]
    v_mfma_f32_16x16x32_bf16 v[56:59], a[40:43], a[16:19], v[56:59]
    v_mfma_f32_16x16x32_bf16 v[92:95], a[16:19], a[44:47], v[92:95]
    ds_read_b128 a[16:19], v113 offset:8192
    s_waitcnt lgkmcnt(14)
    v_mfma_f32_16x16x32_bf16 v[28:31], a[36:39], a[20:23], v[28:31]
    v_mfma_f32_16x16x32_bf16 v[60:63], a[40:43], a[20:23], v[60:63]
    v_mfma_f32_16x16x32_bf16 v[96:99], a[20:23], a[44:47], v[96:99]
    ds_read_b128 a[20:23], v113 offset:10240
    s_waitcnt lgkmcnt(14)
    v_mfma_f32_16x16x32_bf16 v[32:35], a[36:39], a[24:27], v[32:35]
    v_mfma_f32_16x16x32_bf16 v[64:67], a[40:43], a[24:27], v[64:67]
    v_mfma_f32_16x16x32_bf16 v[100:103], a[24:27], a[44:47], v[100:103]
    ds_read_b128 a[24:27], v113 offset:12288
    s_waitcnt lgkmcnt(14)
    v_mfma_f32_16x16x32_bf16 v[36:39], a[36:39], a[28:31], v[36:39]
    v_mfma_f32_16x16x32_bf16 v[68:71], a[40:43], a[28:31], v[68:71]
    v_mfma_f32_16x16x32_bf16 v[104:107], a[28:31], a[44:47], v[104:107]
    ds_read_b128 a[28:31], v113 offset:14336
    s_waitcnt lgkmcnt(14)
    v_mfma_f32_16x16x32_bf16 v[72:75], a[40:43], a[32:35], v[72:75]
    v_mfma_f32_16x16x32_bf16 v[108:111], a[32:35], a[44:47], v[108:111]
    ds_read_b128 a[32:35], v113 offset:16384
    s_waitcnt lgkmcnt(7)
    v_mfma_f32_16x16x32_bf16 v[8:11], a[48:51], a[0:3], v[8:11]
    v_mfma_f32_16x16x32_bf16 v[40:43], a[52:55], a[0:3], v[40:43]
    v_mfma_f32_16x16x32_bf16 v[76:79], a[0:3], a[56:59], v[76:79]
    v_mfma_f32_16x16x32_bf16 v[12:15], a[48:51], a[4:7], v[12:15]
    v_mfma_f32_16x16x32_bf16 v[44:47], a[52:55], a[4:7], v[44:47]
    v_mfma_f32_16x16x32_bf16 v[80:83], a[4:7], a[56:59], v[80:83]
    s_waitcnt lgkmcnt(6)
    v_mfma_f32_16x16x32_bf16 v[16:19], a[48:51], a[8:11], v[16:19]
    v_mfma_f32_16x16x32_bf16 v[48:51], a[52:55], a[8:11], v[48:51]
    v_mfma_f32_16x16x32_bf16 v[84:87], a[8:11], a[56:59], v[84:87]
    s_waitcnt lgkmcnt(0)
    s_barrier
    ds_read_b64_tr_b16 a[36:37], v119 offset:0
    ds_read_b64_tr_b16 a[38:39], v119 offset:512
    v_mfma_f32_16x16x32_bf16 v[20:23], a[48:51], a[12:15], v[20:23]
    ds_read_b64_tr_b16 a[40:41], v119 offset:8192
    v_mfma_f32_16x16x32_bf16 v[52:55], a[52:55], a[12:15], v[52:55]
    ds_read_b64_tr_b16 a[42:43], v119 offset:8704
    v_mfma_f32_16x16x32_bf16 v[88:91], a[12:15], a[56:59], v[88:91]
    ds_read_b64_tr_b16 a[44:45], v119 offset:16384
    v_mfma_f32_16x16x32_bf16 v[24:27], a[48:51], a[16:19], v[24:27]
    ds_read_b64_tr_b16 a[46:47], v119 offset:16896
    v_mfma_f32_16x16x32_bf16 v[56:59], a[52:55], a[16:19], v[56:59]
    ds_read_b128 a[0:3], v114 offset:0
    v_mfma_f32_16x16x32_bf16 v[92:95], a[16:19], a[56:59], v[92:95]
    ds_read_b128 a[4:7], v114 offset:2048
    v_mfma_f32_16x16x32_bf16 v[28:31], a[48:51], a[20:23], v[28:31]
    ds_read_b128 a[8:11], v114 offset:4096
    v_mfma_f32_16x16x32_bf16 v[60:63], a[52:55], a[20:23], v[60:63]
    ds_read_b128 a[12:15], v114 offset:6144
    v_mfma_f32_16x16x32_bf16 v[96:99], a[20:23], a[56:59], v[96:99]
    ds_read_b128 a[16:19], v114 offset:8192
    v_mfma_f32_16x16x32_bf16 v[32:35], a[48:51], a[24:27], v[32:35]
    ds_read_b128 a[20:23], v114 offset:10240
    v_mfma_f32_16x16x32_bf16 v[64:67], a[52:55], a[24:27], v[64:67]
    v_mfma_f32_16x16x32_bf16 v[100:103], a[24:27], a[56:59], v[100:103]
    ds_read_b128 a[24:27], v114 offset:12288
    v_mfma_f32_16x16x32_bf16 v[36:39], a[48:51], a[28:31], v[36:39]
    v_mfma_f32_16x16x32_bf16 v[68:71], a[52:55], a[28:31], v[68:71]
    v_mfma_f32_16x16x32_bf16 v[104:107], a[28:31], a[56:59], v[104:107]
    ds_read_b128 a[28:31], v114 offset:14336
    v_mfma_f32_16x16x32_bf16 v[72:75], a[52:55], a[32:35], v[72:75]
    v_mfma_f32_16x16x32_bf16 v[108:111], a[32:35], a[56:59], v[108:111]
    ds_read_b128 a[32:35], v114 offset:16384
    s_waitcnt lgkmcnt(8)
    v_mfma_f32_16x16x32_bf16 v[8:11], a[36:39], a[0:3], v[8:11]
    ds_read_b64_tr_b16 a[48:49], v119 offset:4096
    v_mfma_f32_16x16x32_bf16 v[40:43], a[40:43], a[0:3], v[40:43]
    ds_read_b64_tr_b16 a[50:51], v119 offset:4608
    v_mfma_f32_16x16x32_bf16 v[76:79], a[0:3], a[44:47], v[76:79]
    ds_read_b128 a[0:3], v115 offset:0
    s_waitcnt lgkmcnt(10)
    v_mfma_f32_16x16x32_bf16 v[12:15], a[36:39], a[4:7], v[12:15]
    ds_read_b64_tr_b16 a[52:53], v119 offset:12288
    v_mfma_f32_16x16x32_bf16 v[44:47], a[40:43], a[4:7], v[44:47]
    ds_read_b64_tr_b16 a[54:55], v119 offset:12800
    v_mfma_f32_16x16x32_bf16 v[80:83], a[4:7], a[44:47], v[80:83]
    ds_read_b128 a[4:7], v115 offset:2048
    s_waitcnt lgkmcnt(12)
    v_mfma_f32_16x16x32_bf16 v[16:19], a[36:39], a[8:11], v[16:19]
    ds_read_b64_tr_b16 a[56:57], v119 offset:20480
    v_mfma_f32_16x16x32_bf16 v[48:51], a[40:43], a[8:11], v[48:51]
    ds_read_b64_tr_b16 a[58:59], v119 offset:20992
    v_mfma_f32_16x16x32_bf16 v[84:87], a[8:11], a[44:47], v[84:87]
    ds_read_b128 a[8:11], v115 offset:4096
    s_waitcnt lgkmcnt(14)
    v_mfma_f32_16x16x32_bf16 v[20:23], a[36:39], a[12:15], v[20:23]
    v_mfma_f32_16x16x32_bf16 v[52:55], a[40:43], a[12:15], v[52:55]
    v_mfma_f32_16x16x32_bf16 v[88:91], a[12:15], a[44:47], v[88:91]
    ds_read_b128 a[12:15], v115 offset:6144
    s_waitcnt lgkmcnt(14)
    v_mfma_f32_16x16x32_bf16 v[24:27], a[36:39], a[16:19], v[24:27]
    v_mfma_f32_16x16x32_bf16 v[56:59], a[40:43], a[16:19], v[56:59]
    v_mfma_f32_16x16x32_bf16 v[92:95], a[16:19], a[44:47], v[92:95]
    ds_read_b128 a[16:19], v115 offset:8192
    s_waitcnt lgkmcnt(14)
    v_mfma_f32_16x16x32_bf16 v[28:31], a[36:39], a[20:23], v[28:31]
    v_mfma_f32_16x16x32_bf16 v[60:63], a[40:43], a[20:23], v[60:63]
    v_mfma_f32_16x16x32_bf16 v[96:99], a[20:23], a[44:47], v[96:99]
    ds_read_b128 a[20:23], v115 offset:10240
    s_waitcnt lgkmcnt(14)
    v_mfma_f32_16x16x32_bf16 v[32:35], a[36:39], a[24:27], v[32:35]
    v_mfma_f32_16x16x32_bf16 v[64:67], a[40:43], a[24:27], v[64:67]
    v_mfma_f32_16x16x32_bf16 v[100:103], a[24:27], a[44:47], v[100:103]
    ds_read_b128 a[24:27], v115 offset:12288
    s_waitcnt lgkmcnt(14)
    v_mfma_f32_16x16x32_bf16 v[36:39], a[36:39], a[28:31], v[36:39]
    v_mfma_f32_16x16x32_bf16 v[68:71], a[40:43], a[28:31], v[68:71]
    v_mfma_f32_16x16x32_bf16 v[104:107], a[28:31], a[44:47], v[104:107]
    ds_read_b128 a[28:31], v115 offset:14336
    s_waitcnt lgkmcnt(14)
    v_mfma_f32_16x16x32_bf16 v[72:75], a[40:43], a[32:35], v[72:75]
    v_mfma_f32_16x16x32_bf16 v[108:111], a[32:35], a[44:47], v[108:111]
    ds_read_b128 a[32:35], v115 offset:16384
    s_waitcnt lgkmcnt(7)
    v_mfma_f32_16x16x32_bf16 v[8:11], a[48:51], a[0:3], v[8:11]
    v_mfma_f32_16x16x32_bf16 v[40:43], a[52:55], a[0:3], v[40:43]
    v_mfma_f32_16x16x32_bf16 v[76:79], a[0:3], a[56:59], v[76:79]
    v_mfma_f32_16x16x32_bf16 v[12:15], a[48:51], a[4:7], v[12:15]
    v_mfma_f32_16x16x32_bf16 v[44:47], a[52:55], a[4:7], v[44:47]
    v_mfma_f32_16x16x32_bf16 v[80:83], a[4:7], a[56:59], v[80:83]
    s_waitcnt lgkmcnt(6)
    v_mfma_f32_16x16x32_bf16 v[16:19], a[48:51], a[8:11], v[16:19]
    v_mfma_f32_16x16x32_bf16 v[48:51], a[52:55], a[8:11], v[48:51]
    v_mfma_f32_16x16x32_bf16 v[84:87], a[8:11], a[56:59], v[84:87]
    s_waitcnt lgkmcnt(0)
    s_barrier
    ds_read_b64_tr_b16 a[36:37], v120 offset:0
    ds_read_b64_tr_b16 a[38:39], v120 offset:512
    v_mfma_f32_16x16x32_bf16 v[20:23], a[48:51], a[12:15], v[20:23]
    ds_read_b64_tr_b16 a[40:41], v120 offset:8192
    v_mfma_f32_16x16x32_bf16 v[52:55], a[52:55], a[12:15], v[52:55]
    ds_read_b64_tr_b16 a[42:43], v120 offset:8704
    v_mfma_f32_16x16x32_bf16 v[88:91], a[12:15], a[56:59], v[88:91]
    ds_read_b64_tr_b16 a[44:45], v120 offset:16384
    v_mfma_f32_16x16x32_bf16 v[24:27], a[48:51], a[16:19], v[24:27]
    ds_read_b64_tr_b16 a[46:47], v120 offset:16896
    v_mfma_f32_16x16x32_bf16 v[56:59], a[52:55], a[16:19], v[56:59]
    ds_read_b128 a[0:3], v116 offset:0
    v_mfma_f32_16x16x32_bf16 v[92:95], a[16:19], a[56:59], v[92:95]
    ds_read_b128 a[4:7], v116 offset:2048
    v_mfma_f32_16x16x32_bf16 v[28:31], a[48:51], a[20:23], v[28:31]
    ds_read_b128 a[8:11], v116 offset:4096
    v_mfma_f32_16x16x32_bf16 v[60:63], a[52:55], a[20:23], v[60:63]
    ds_read_b128 a[12:15], v116 offset:6144
    v_mfma_f32_16x16x32_bf16 v[96:99], a[20:23], a[56:59], v[96:99]
    ds_read_b128 a[16:19], v116 offset:8192
    v_mfma_f32_16x16x32_bf16 v[32:35], a[48:51], a[24:27], v[32:35]
    ds_read_b128 a[20:23], v116 offset:10240
    v_mfma_f32_16x16x32_bf16 v[64:67], a[52:55], a[24:27], v[64:67]
    v_mfma_f32_16x16x32_bf16 v[100:103], a[24:27], a[56:59], v[100:103]
    ds_read_b128 a[24:27], v116 offset:12288
    v_mfma_f32_16x16x32_bf16 v[36:39], a[48:51], a[28:31], v[36:39]
    v_mfma_f32_16x16x32_bf16 v[68:71], a[52:55], a[28:31], v[68:71]
    v_mfma_f32_16x16x32_bf16 v[104:107], a[28:31], a[56:59], v[104:107]
    ds_read_b128 a[28:31], v116 offset:14336
    v_mfma_f32_16x16x32_bf16 v[72:75], a[52:55], a[32:35], v[72:75]
    v_mfma_f32_16x16x32_bf16 v[108:111], a[32:35], a[56:59], v[108:111]
    ds_read_b128 a[32:35], v116 offset:16384
    s_waitcnt lgkmcnt(8)
    v_mfma_f32_16x16x32_bf16 v[8:11], a[36:39], a[0:3], v[8:11]
    ds_read_b64_tr_b16 a[48:49], v120 offset:4096
    v_mfma_f32_16x16x32_bf16 v[40:43], a[40:43], a[0:3], v[40:43]
    ds_read_b64_tr_b16 a[50:51], v120 offset:4608
    v_mfma_f32_16x16x32_bf16 v[76:79], a[0:3], a[44:47], v[76:79]
    ds_read_b128 a[0:3], v117 offset:0
    s_waitcnt lgkmcnt(10)
    v_mfma_f32_16x16x32_bf16 v[12:15], a[36:39], a[4:7], v[12:15]
    ds_read_b64_tr_b16 a[52:53], v120 offset:12288
    v_mfma_f32_16x16x32_bf16 v[44:47], a[40:43], a[4:7], v[44:47]
    ds_read_b64_tr_b16 a[54:55], v120 offset:12800
    v_mfma_f32_16x16x32_bf16 v[80:83], a[4:7], a[44:47], v[80:83]
    ds_read_b128 a[4:7], v117 offset:2048
    s_waitcnt lgkmcnt(12)
    v_mfma_f32_16x16x32_bf16 v[16:19], a[36:39], a[8:11], v[16:19]
    ds_read_b64_tr_b16 a[56:57], v120 offset:20480
    v_mfma_f32_16x16x32_bf16 v[48:51], a[40:43], a[8:11], v[48:51]
    ds_read_b64_tr_b16 a[58:59], v120 offset:20992
    v_mfma_f32_16x16x32_bf16 v[84:87], a[8:11], a[44:47], v[84:87]
    ds_read_b128 a[8:11], v117 offset:4096
    s_waitcnt lgkmcnt(14)
    v_mfma_f32_16x16x32_bf16 v[20:23], a[36:39], a[12:15], v[20:23]
    v_mfma_f32_16x16x32_bf16 v[52:55], a[40:43], a[12:15], v[52:55]
    v_mfma_f32_16x16x32_bf16 v[88:91], a[12:15], a[44:47], v[88:91]
    ds_read_b128 a[12:15], v117 offset:6144
    s_waitcnt lgkmcnt(14)
    v_mfma_f32_16x16x32_bf16 v[24:27], a[36:39], a[16:19], v[24:27]
    v_mfma_f32_16x16x32_bf16 v[56:59], a[40:43], a[16:19], v[56:59]
    v_mfma_f32_16x16x32_bf16 v[92:95], a[16:19], a[44:47], v[92:95]
    ds_read_b128 a[16:19], v117 offset:8192
    s_waitcnt lgkmcnt(14)
    v_mfma_f32_16x16x32_bf16 v[28:31], a[36:39], a[20:23], v[28:31]
    v_mfma_f32_16x16x32_bf16 v[60:63], a[40:43], a[20:23], v[60:63]
    v_mfma_f32_16x16x32_bf16 v[96:99], a[20:23], a[44:47], v[96:99]
    ds_read_b128 a[20:23], v117 offset:10240
    s_waitcnt lgkmcnt(14)
    v_mfma_f32_16x16x32_bf16 v[32:35], a[36:39], a[24:27], v[32:35]
    v_mfma_f32_16x16x32_bf16 v[64:67], a[40:43], a[24:27], v[64:67]
    v_mfma_f32_16x16x32_bf16 v[100:103], a[24:27], a[44:47], v[100:103]
    ds_read_b128 a[24:27], v117 offset:12288
    s_waitcnt lgkmcnt(14)
    v_mfma_f32_16x16x32_bf16 v[36:39], a[36:39], a[28:31], v[36:39]
    v_mfma_f32_16x16x32_bf16 v[68:71], a[40:43], a[28:31], v[68:71]
    v_mfma_f32_16x16x32_bf16 v[104:107], a[28:31], a[44:47], v[104:107]
    ds_read_b128 a[28:31], v117 offset:14336
    s_waitcnt lgkmcnt(14)
    v_mfma_f32_16x16x32_bf16 v[72:75], a[40:43], a[32:35], v[72:75]
    v_mfma_f32_16x16x32_bf16 v[108:111], a[32:35], a[44:47], v[108:111]
    ds_read_b128 a[32:35], v117 offset:16384
    s_waitcnt lgkmcnt(7)
    v_mfma_f32_16x16x32_bf16 v[8:11], a[48:51], a[0:3], v[8:11]
    v_mfma_f32_16x16x32_bf16 v[40:43], a[52:55], a[0:3], v[40:43]
    v_mfma_f32_16x16x32_bf16 v[76:79], a[0:3], a[56:59], v[76:79]
    v_mfma_f32_16x16x32_bf16 v[12:15], a[48:51], a[4:7], v[12:15]
    v_mfma_f32_16x16x32_bf16 v[44:47], a[52:55], a[4:7], v[44:47]
    v_mfma_f32_16x16x32_bf16 v[80:83], a[4:7], a[56:59], v[80:83]
    s_waitcnt lgkmcnt(6)
    v_mfma_f32_16x16x32_bf16 v[16:19], a[48:51], a[8:11], v[16:19]
    v_mfma_f32_16x16x32_bf16 v[48:51], a[52:55], a[8:11], v[48:51]
    v_mfma_f32_16x16x32_bf16 v[84:87], a[8:11], a[56:59], v[84:87]
    s_waitcnt lgkmcnt(0)
    s_barrier
    ds_read_b64_tr_b16 a[36:37], v118 offset:0
    ds_read_b64_tr_b16 a[38:39], v118 offset:512
    v_mfma_f32_16x16x32_bf16 v[20:23], a[48:51], a[12:15], v[20:23]
    ds_read_b64_tr_b16 a[40:41], v118 offset:8192
    v_mfma_f32_16x16x32_bf16 v[52:55], a[52:55], a[12:15], v[52:55]
    ds_read_b64_tr_b16 a[42:43], v118 offset:8704
    v_mfma_f32_16x16x32_bf16 v[88:91], a[12:15], a[56:59], v[88:91]
    ds_read_b64_tr_b16 a[44:45], v118 offset:16384
    v_mfma_f32_16x16x32_bf16 v[24:27], a[48:51], a[16:19], v[24:27]
    ds_read_b64_tr_b16 a[46:47], v118 offset:16896
    v_mfma_f32_16x16x32_bf16 v[56:59], a[52:55], a[16:19], v[56:59]
    ds_read_b128 a[0:3], v112 offset:0
    v_mfma_f32_16x16x32_bf16 v[92:95], a[16:19], a[56:59], v[92:95]
    ds_read_b128 a[4:7], v112 offset:2048
    v_mfma_f32_16x16x32_bf16 v[28:31], a[48:51], a[20:23], v[28:31]
    ds_read_b128 a[8:11], v112 offset:4096
    v_mfma_f32_16x16x32_bf16 v[60:63], a[52:55], a[20:23], v[60:63]
    ds_read_b128 a[12:15], v112 offset:6144
    v_mfma_f32_16x16x32_bf16 v[96:99], a[20:23], a[56:59], v[96:99]
    ds_read_b128 a[16:19], v112 offset:8192
    v_mfma_f32_16x16x32_bf16 v[32:35], a[48:51], a[24:27], v[32:35]
    ds_read_b128 a[20:23], v112 offset:10240
    v_mfma_f32_16x16x32_bf16 v[64:67], a[52:55], a[24:27], v[64:67]
    v_mfma_f32_16x16x32_bf16 v[100:103], a[24:27], a[56:59], v[100:103]
    ds_read_b128 a[24:27], v112 offset:12288
    v_mfma_f32_16x16x32_bf16 v[36:39], a[48:51], a[28:31], v[36:39]
    v_mfma_f32_16x16x32_bf16 v[68:71], a[52:55], a[28:31], v[68:71]
    v_mfma_f32_16x16x32_bf16 v[104:107], a[28:31], a[56:59], v[104:107]
    ds_read_b128 a[28:31], v112 offset:14336
    v_mfma_f32_16x16x32_bf16 v[72:75], a[52:55], a[32:35], v[72:75]
    v_mfma_f32_16x16x32_bf16 v[108:111], a[32:35], a[56:59], v[108:111]
    ds_read_b128 a[32:35], v112 offset:16384
    s_waitcnt lgkmcnt(8)
    v_mfma_f32_16x16x32_bf16 v[8:11], a[36:39], a[0:3], v[8:11]
    ds_read_b64_tr_b16 a[48:49], v118 offset:4096
    v_mfma_f32_16x16x32_bf16 v[40:43], a[40:43], a[0:3], v[40:43]
    ds_read_b64_tr_b16 a[50:51], v118 offset:4608
    v_mfma_f32_16x16x32_bf16 v[76:79], a[0:3], a[44:47], v[76:79]
    ds_read_b128 a[0:3], v113 offset:0
    s_waitcnt lgkmcnt(10)
    v_mfma_f32_16x16x32_bf16 v[12:15], a[36:39], a[4:7], v[12:15]
    ds_read_b64_tr_b16 a[52:53], v118 offset:12288
    v_mfma_f32_16x16x32_bf16 v[44:47], a[40:43], a[4:7], v[44:47]
    ds_read_b64_tr_b16 a[54:55], v118 offset:12800
    v_mfma_f32_16x16x32_bf16 v[80:83], a[4:7], a[44:47], v[80:83]
    ds_read_b128 a[4:7], v113 offset:2048
    s_waitcnt lgkmcnt(12)
    v_mfma_f32_16x16x32_bf16 v[16:19], a[36:39], a[8:11], v[16:19]
    ds_read_b64_tr_b16 a[56:57], v118 offset:20480
    v_mfma_f32_16x16x32_bf16 v[48:51], a[40:43], a[8:11], v[48:51]
    ds_read_b64_tr_b16 a[58:59], v118 offset:20992
    v_mfma_f32_16x16x32_bf16 v[84:87], a[8:11], a[44:47], v[84:87]
    ds_read_b128 a[8:11], v113 offset:4096
    s_waitcnt lgkmcnt(14)
    v_mfma_f32_16x16x32_bf16 v[20:23], a[36:39], a[12:15], v[20:23]
    v_mfma_f32_16x16x32_bf16 v[52:55], a[40:43], a[12:15], v[52:55]
    v_mfma_f32_16x16x32_bf16 v[88:91], a[12:15], a[44:47], v[88:91]
    ds_read_b128 a[12:15], v113 offset:6144
    s_waitcnt lgkmcnt(14)
    v_mfma_f32_16x16x32_bf16 v[24:27], a[36:39], a[16:19], v[24:27]
    v_mfma_f32_16x16x32_bf16 v[56:59], a[40:43], a[16:19], v[56:59]
    v_mfma_f32_16x16x32_bf16 v[92:95], a[16:19], a[44:47], v[92:95]
    ds_read_b128 a[16:19], v113 offset:8192
    s_waitcnt lgkmcnt(14)
    v_mfma_f32_16x16x32_bf16 v[28:31], a[36:39], a[20:23], v[28:31]
    v_mfma_f32_16x16x32_bf16 v[60:63], a[40:43], a[20:23], v[60:63]
    v_mfma_f32_16x16x32_bf16 v[96:99], a[20:23], a[44:47], v[96:99]
    ds_read_b128 a[20:23], v113 offset:10240
    s_waitcnt lgkmcnt(14)
    v_mfma_f32_16x16x32_bf16 v[32:35], a[36:39], a[24:27], v[32:35]
    v_mfma_f32_16x16x32_bf16 v[64:67], a[40:43], a[24:27], v[64:67]
    v_mfma_f32_16x16x32_bf16 v[100:103], a[24:27], a[44:47], v[100:103]
    ds_read_b128 a[24:27], v113 offset:12288
    s_waitcnt lgkmcnt(14)
    v_mfma_f32_16x16x32_bf16 v[36:39], a[36:39], a[28:31], v[36:39]
    v_mfma_f32_16x16x32_bf16 v[68:71], a[40:43], a[28:31], v[68:71]
    v_mfma_f32_16x16x32_bf16 v[104:107], a[28:31], a[44:47], v[104:107]
    ds_read_b128 a[28:31], v113 offset:14336
    s_waitcnt lgkmcnt(14)
    v_mfma_f32_16x16x32_bf16 v[72:75], a[40:43], a[32:35], v[72:75]
    v_mfma_f32_16x16x32_bf16 v[108:111], a[32:35], a[44:47], v[108:111]
    ds_read_b128 a[32:35], v113 offset:16384
    s_waitcnt lgkmcnt(7)
    v_mfma_f32_16x16x32_bf16 v[8:11], a[48:51], a[0:3], v[8:11]
    v_mfma_f32_16x16x32_bf16 v[40:43], a[52:55], a[0:3], v[40:43]
    v_mfma_f32_16x16x32_bf16 v[76:79], a[0:3], a[56:59], v[76:79]
    v_mfma_f32_16x16x32_bf16 v[12:15], a[48:51], a[4:7], v[12:15]
    v_mfma_f32_16x16x32_bf16 v[44:47], a[52:55], a[4:7], v[44:47]
    v_mfma_f32_16x16x32_bf16 v[80:83], a[4:7], a[56:59], v[80:83]
    s_waitcnt lgkmcnt(6)
    v_mfma_f32_16x16x32_bf16 v[16:19], a[48:51], a[8:11], v[16:19]
    v_mfma_f32_16x16x32_bf16 v[48:51], a[52:55], a[8:11], v[48:51]
    v_mfma_f32_16x16x32_bf16 v[84:87], a[8:11], a[56:59], v[84:87]
    s_waitcnt lgkmcnt(0)
    s_barrier
    ds_read_b64_tr_b16 a[36:37], v119 offset:0
    ds_read_b64_tr_b16 a[38:39], v119 offset:512
    v_mfma_f32_16x16x32_bf16 v[20:23], a[48:51], a[12:15], v[20:23]
    ds_read_b64_tr_b16 a[40:41], v119 offset:8192
    v_mfma_f32_16x16x32_bf16 v[52:55], a[52:55], a[12:15], v[52:55]
    ds_read_b64_tr_b16 a[42:43], v119 offset:8704
    v_mfma_f32_16x16x32_bf16 v[88:91], a[12:15], a[56:59], v[88:91]
    ds_read_b64_tr_b16 a[44:45], v119 offset:16384
    v_mfma_f32_16x16x32_bf16 v[24:27], a[48:51], a[16:19], v[24:27]
    ds_read_b64_tr_b16 a[46:47], v119 offset:16896
    v_mfma_f32_16x16x32_bf16 v[56:59], a[52:55], a[16:19], v[56:59]
    ds_read_b128 a[0:3], v114 offset:0
    v_mfma_f32_16x16x32_bf16 v[92:95], a[16:19], a[56:59], v[92:95]
    ds_read_b128 a[4:7], v114 offset:2048
    v_mfma_f32_16x16x32_bf16 v[28:31], a[48:51], a[20:23], v[28:31]
    ds_read_b128 a[8:11], v114 offset:4096
    v_mfma_f32_16x16x32_bf16 v[60:63], a[52:55], a[20:23], v[60:63]
    ds_read_b128 a[12:15], v114 offset:6144
    v_mfma_f32_16x16x32_bf16 v[96:99], a[20:23], a[56:59], v[96:99]
    ds_read_b128 a[16:19], v114 offset:8192
    v_mfma_f32_16x16x32_bf16 v[32:35], a[48:51], a[24:27], v[32:35]
    ds_read_b128 a[20:23], v114 offset:10240
    v_mfma_f32_16x16x32_bf16 v[64:67], a[52:55], a[24:27], v[64:67]
    v_mfma_f32_16x16x32_bf16 v[100:103], a[24:27], a[56:59], v[100:103]
    ds_read_b128 a[24:27], v114 offset:12288
    v_mfma_f32_16x16x32_bf16 v[36:39], a[48:51], a[28:31], v[36:39]
    v_mfma_f32_16x16x32_bf16 v[68:71], a[52:55], a[28:31], v[68:71]
    v_mfma_f32_16x16x32_bf16 v[104:107], a[28:31], a[56:59], v[104:107]
    ds_read_b128 a[28:31], v114 offset:14336
    v_mfma_f32_16x16x32_bf16 v[72:75], a[52:55], a[32:35], v[72:75]
    v_mfma_f32_16x16x32_bf16 v[108:111], a[32:35], a[56:59], v[108:111]
    ds_read_b128 a[32:35], v114 offset:16384
    s_waitcnt lgkmcnt(8)
    v_mfma_f32_16x16x32_bf16 v[8:11], a[36:39], a[0:3], v[8:11]
    ds_read_b64_tr_b16 a[48:49], v119 offset:4096
    v_mfma_f32_16x16x32_bf16 v[40:43], a[40:43], a[0:3], v[40:43]
    ds_read_b64_tr_b16 a[50:51], v119 offset:4608
    v_mfma_f32_16x16x32_bf16 v[76:79], a[0:3], a[44:47], v[76:79]
    ds_read_b128 a[0:3], v115 offset:0
    s_waitcnt lgkmcnt(10)
    v_mfma_f32_16x16x32_bf16 v[12:15], a[36:39], a[4:7], v[12:15]
    ds_read_b64_tr_b16 a[52:53], v119 offset:12288
    v_mfma_f32_16x16x32_bf16 v[44:47], a[40:43], a[4:7], v[44:47]
    ds_read_b64_tr_b16 a[54:55], v119 offset:12800
    v_mfma_f32_16x16x32_bf16 v[80:83], a[4:7], a[44:47], v[80:83]
    ds_read_b128 a[4:7], v115 offset:2048
    s_waitcnt lgkmcnt(12)
    v_mfma_f32_16x16x32_bf16 v[16:19], a[36:39], a[8:11], v[16:19]
    ds_read_b64_tr_b16 a[56:57], v119 offset:20480
    v_mfma_f32_16x16x32_bf16 v[48:51], a[40:43], a[8:11], v[48:51]
    ds_read_b64_tr_b16 a[58:59], v119 offset:20992
    v_mfma_f32_16x16x32_bf16 v[84:87], a[8:11], a[44:47], v[84:87]
    ds_read_b128 a[8:11], v115 offset:4096
    s_waitcnt lgkmcnt(14)
    v_mfma_f32_16x16x32_bf16 v[20:23], a[36:39], a[12:15], v[20:23]
    v_mfma_f32_16x16x32_bf16 v[52:55], a[40:43], a[12:15], v[52:55]
    v_mfma_f32_16x16x32_bf16 v[88:91], a[12:15], a[44:47], v[88:91]
    ds_read_b128 a[12:15], v115 offset:6144
    s_waitcnt lgkmcnt(14)
    v_mfma_f32_16x16x32_bf16 v[24:27], a[36:39], a[16:19], v[24:27]
    v_mfma_f32_16x16x32_bf16 v[56:59], a[40:43], a[16:19], v[56:59]
    v_mfma_f32_16x16x32_bf16 v[92:95], a[16:19], a[44:47], v[92:95]
    ds_read_b128 a[16:19], v115 offset:8192
    s_waitcnt lgkmcnt(14)
    v_mfma_f32_16x16x32_bf16 v[28:31], a[36:39], a[20:23], v[28:31]
    v_mfma_f32_16x16x32_bf16 v[60:63], a[40:43], a[20:23], v[60:63]
    v_mfma_f32_16x16x32_bf16 v[96:99], a[20:23], a[44:47], v[96:99]
    ds_read_b128 a[20:23], v115 offset:10240
    s_waitcnt lgkmcnt(14)
    v_mfma_f32_16x16x32_bf16 v[32:35], a[36:39], a[24:27], v[32:35]
    v_mfma_f32_16x16x32_bf16 v[64:67], a[40:43], a[24:27], v[64:67]
    v_mfma_f32_16x16x32_bf16 v[100:103], a[24:27], a[44:47], v[100:103]
    ds_read_b128 a[24:27], v115 offset:12288
    s_waitcnt lgkmcnt(14)
    v_mfma_f32_16x16x32_bf16 v[36:39], a[36:39], a[28:31], v[36:39]
    v_mfma_f32_16x16x32_bf16 v[68:71], a[40:43], a[28:31], v[68:71]
    v_mfma_f32_16x16x32_bf16 v[104:107], a[28:31], a[44:47], v[104:107]
    ds_read_b128 a[28:31], v115 offset:14336
    s_waitcnt lgkmcnt(14)
    v_mfma_f32_16x16x32_bf16 v[72:75], a[40:43], a[32:35], v[72:75]
    v_mfma_f32_16x16x32_bf16 v[108:111], a[32:35], a[44:47], v[108:111]
    ds_read_b128 a[32:35], v115 offset:16384
    s_waitcnt lgkmcnt(7)
    v_mfma_f32_16x16x32_bf16 v[8:11], a[48:51], a[0:3], v[8:11]
    v_mfma_f32_16x16x32_bf16 v[40:43], a[52:55], a[0:3], v[40:43]
    v_mfma_f32_16x16x32_bf16 v[76:79], a[0:3], a[56:59], v[76:79]
    v_mfma_f32_16x16x32_bf16 v[12:15], a[48:51], a[4:7], v[12:15]
    v_mfma_f32_16x16x32_bf16 v[44:47], a[52:55], a[4:7], v[44:47]
    v_mfma_f32_16x16x32_bf16 v[80:83], a[4:7], a[56:59], v[80:83]
    s_waitcnt lgkmcnt(6)
    v_mfma_f32_16x16x32_bf16 v[16:19], a[48:51], a[8:11], v[16:19]
    v_mfma_f32_16x16x32_bf16 v[48:51], a[52:55], a[8:11], v[48:51]
    v_mfma_f32_16x16x32_bf16 v[84:87], a[8:11], a[56:59], v[84:87]
    s_waitcnt lgkmcnt(0)
    s_barrier
    v_mfma_f32_16x16x32_bf16 v[20:23], a[48:51], a[12:15], v[20:23]
    v_mfma_f32_16x16x32_bf16 v[52:55], a[52:55], a[12:15], v[52:55]
    v_mfma_f32_16x16x32_bf16 v[88:91], a[12:15], a[56:59], v[88:91]
    v_cvt_pk_bf16_f32 v142, v76, v77
    v_cvt_pk_bf16_f32 v143, v78, v79
    v_cvt_pk_bf16_f32 v76, v40, v41
    v_cvt_pk_bf16_f32 v77, v42, v43
    v_mfma_f32_16x16x32_bf16 v[24:27], a[48:51], a[16:19], v[24:27]
    v_mfma_f32_16x16x32_bf16 v[56:59], a[52:55], a[16:19], v[56:59]
    v_mfma_f32_16x16x32_bf16 v[92:95], a[16:19], a[56:59], v[92:95]
    v_cvt_pk_bf16_f32 v152, v80, v81
    v_cvt_pk_bf16_f32 v153, v82, v83
    v_cvt_pk_bf16_f32 v78, v44, v45
    v_cvt_pk_bf16_f32 v79, v46, v47
    v_mfma_f32_16x16x32_bf16 v[28:31], a[48:51], a[20:23], v[28:31]
    v_mfma_f32_16x16x32_bf16 v[60:63], a[52:55], a[20:23], v[60:63]
    v_mfma_f32_16x16x32_bf16 v[96:99], a[20:23], a[56:59], v[96:99]
    v_cvt_pk_bf16_f32 v144, v84, v85
    v_cvt_pk_bf16_f32 v145, v86, v87
    v_cvt_pk_bf16_f32 v80, v48, v49
    v_cvt_pk_bf16_f32 v81, v50, v51
    v_mfma_f32_16x16x32_bf16 v[32:35], a[48:51], a[24:27], v[32:35]
    v_mfma_f32_16x16x32_bf16 v[64:67], a[52:55], a[24:27], v[64:67]
    v_mfma_f32_16x16x32_bf16 v[100:103], a[24:27], a[56:59], v[100:103]
    v_cvt_pk_bf16_f32 v154, v88, v89
    v_cvt_pk_bf16_f32 v155, v90, v91
    v_cvt_pk_bf16_f32 v82, v52, v53
    v_cvt_pk_bf16_f32 v83, v54, v55
    v_mfma_f32_16x16x32_bf16 v[36:39], a[48:51], a[28:31], v[36:39]
    v_mfma_f32_16x16x32_bf16 v[68:71], a[52:55], a[28:31], v[68:71]
    v_mfma_f32_16x16x32_bf16 v[104:107], a[28:31], a[56:59], v[104:107]
    v_cvt_pk_bf16_f32 v146, v92, v93
    v_cvt_pk_bf16_f32 v147, v94, v95
    v_cvt_pk_bf16_f32 v84, v56, v57
    v_cvt_pk_bf16_f32 v85, v58, v59
    v_mfma_f32_16x16x32_bf16 v[72:75], a[52:55], a[32:35], v[72:75]
    v_mfma_f32_16x16x32_bf16 v[108:111], a[32:35], a[56:59], v[108:111]
    v_cvt_pk_bf16_f32 v156, v96, v97
    v_cvt_pk_bf16_f32 v157, v98, v99
    v_cvt_pk_bf16_f32 v86, v60, v61
    v_cvt_pk_bf16_f32 v87, v62, v63
    s_waitcnt vmcnt(0)
L_epiB:
    v_cvt_pk_bf16_f32 v148, v100, v101
    v_cvt_pk_bf16_f32 v149, v102, v103
    v_cvt_pk_bf16_f32 v158, v104, v105
    v_cvt_pk_bf16_f32 v159, v106, v107
    v_cvt_pk_bf16_f32 v140, v108, v109
    v_cvt_pk_bf16_f32 v141, v110, v111
    v_mov_b32 v150, v140
    v_mov_b32 v151, v141
    v_cvt_pk_bf16_f32 v88, v64, v65
    v_cvt_pk_bf16_f32 v89, v66, v67
    v_cvt_pk_bf16_f32 v90, v68, v69
    v_cvt_pk_bf16_f32 v91, v70, v71
    v_cvt_pk_bf16_f32 v92, v72, v73
    v_cvt_pk_bf16_f32 v93, v74, v75
    v_cvt_pk_bf16_f32 v94, v8, v9
    v_cvt_pk_bf16_f32 v95, v10, v11
    v_cvt_pk_bf16_f32 v96, v12, v13
    v_cvt_pk_bf16_f32 v97, v14, v15
    v_cvt_pk_bf16_f32 v98, v16, v17
    v_cvt_pk_bf16_f32 v99, v18, v19
    v_cvt_pk_bf16_f32 v100, v20, v21
    v_cvt_pk_bf16_f32 v101, v22, v23
    v_cvt_pk_bf16_f32 v102, v24, v25
    v_cvt_pk_bf16_f32 v103, v26, v27
    v_cvt_pk_bf16_f32 v104, v28, v29
    v_cvt_pk_bf16_f32 v105, v30, v31
    v_cvt_pk_bf16_f32 v106, v32, v33
    v_cvt_pk_bf16_f32 v107, v34, v35
    v_cvt_pk_bf16_f32 v108, v36, v37
    v_cvt_pk_bf16_f32 v109, v38, v39
    v_mov_b32 v112, 0x3f803f80
    v_mov_b32 v113, 0x3f803f80
    v_mov_b32 v114, 0x3f803f80
    v_mov_b32 v115, 0x3f803f80
    v_mfma_f32_16x16x16_bf16 v[8:11], v[92:93], v[94:95], v[130:133]
    v_mfma_f32_16x16x16_bf16 v[24:27], v[92:93], v[96:97], v[134:137]
    v_mfma_f32_16x16x16_bf16 v[40:43], v[76:77], v[98:99], v[126:129]
    v_mfma_f32_16x16x16_bf16 v[56:59], v[78:79], v[100:101], v[126:129]
    v_mfma_f32_16x16x16_bf16 v[12:15], v[76:77], v[94:95], v[122:125]
    v_mfma_f32_16x16x16_bf16 v[28:31], v[78:79], v[96:97], v[122:125]
    v_mfma_f32_16x16x16_bf16 v[44:47], v[80:81], v[98:99], v[122:125]
    v_mfma_f32_16x16x16_bf16 v[60:63], v[82:83], v[100:101], v[122:125]
    s_nop 4
    v_max_f32 v12, v12, v8
    v_max_f32 v28, v28, v24
    v_max_f32 v44, v44, v40
    v_max_f32 v60, v60, v56
    v_max_f32 v13, v13, v9
    v_max_f32 v29, v29, v25
    v_max_f32 v45, v45, v41
    v_max_f32 v61, v61, v57
    v_max_f32 v14, v14, v10
    v_max_f32 v30, v30, v26
    v_max_f32 v46, v46, v42
    v_max_f32 v62, v62, v58
    v_max_f32 v15, v15, v11
    v_max_f32 v31, v31, v27
    v_max_f32 v47, v47, v43
    v_max_f32 v63, v63, v59
    v_max3_f32 v20, v12, v13, v14
    v_max3_f32 v36, v28, v29, v30
    v_max3_f32 v52, v44, v45, v46
    v_max3_f32 v68, v60, v61, v62
    v_max_f32 v20, v20, v15
    v_max_f32 v36, v36, v31
    v_max_f32 v52, v52, v47
    v_max_f32 v68, v68, v63
    v_mov_b32 v21, v20
    v_mov_b32 v37, v36
    v_mov_b32 v53, v52
    v_mov_b32 v69, v68
    v_permlane16_swap_b32 v20, v21
    v_permlane16_swap_b32 v36, v37
    v_permlane16_swap_b32 v52, v53
    v_permlane16_swap_b32 v68, v69
    v_max_f32 v20, v20, v21
    v_max_f32 v36, v36, v37
    v_max_f32 v52, v52, v53
    v_max_f32 v68, v68, v69
    v_mov_b32 v21, v20
    v_mov_b32 v37, v36
    v_mov_b32 v53, v52
    v_mov_b32 v69, v68
    v_permlane32_swap_b32 v20, v21
    v_permlane32_swap_b32 v36, v37
    v_permlane32_swap_b32 v52, v53
    v_permlane32_swap_b32 v68, v69
    v_max_f32 v20, v20, v21
    v_max_f32 v36, v36, v37
    v_max_f32 v52, v52, v53
    v_max_f32 v68, v68, v69
    v_mul_f32 v20, s70, v20
    v_mul_f32 v36, s70, v36
    v_mul_f32 v52, s70, v52
    v_mul_f32 v68, s70, v68
    v_pk_fma_f32 v[12:13], v[12:13], s[70:71], v[20:21] op_sel_hi:[1,1,0] neg_lo:[0,0,1] neg_hi:[0,0,1]
    v_pk_fma_f32 v[28:29], v[28:29], s[70:71], v[36:37] op_sel_hi:[1,1,0] neg_lo:[0,0,1] neg_hi:[0,0,1]
    v_pk_fma_f32 v[44:45], v[44:45], s[70:71], v[52:53] op_sel_hi:[1,1,0] neg_lo:[0,0,1] neg_hi:[0,0,1]
    v_pk_fma_f32 v[60:61], v[60:61], s[70:71], v[68:69] op_sel_hi:[1,1,0] neg_lo:[0,0,1] neg_hi:[0,0,1]
    v_pk_fma_f32 v[14:15], v[14:15], s[70:71], v[20:21] op_sel_hi:[1,1,0] neg_lo:[0,0,1] neg_hi:[0,0,1]
    v_pk_fma_f32 v[30:31], v[30:31], s[70:71], v[36:37] op_sel_hi:[1,1,0] neg_lo:[0,0,1] neg_hi:[0,0,1]
    v_pk_fma_f32 v[46:47], v[46:47], s[70:71], v[52:53] op_sel_hi:[1,1,0] neg_lo:[0,0,1] neg_hi:[0,0,1]
    v_pk_fma_f32 v[62:63], v[62:63], s[70:71], v[68:69] op_sel_hi:[1,1,0] neg_lo:[0,0,1] neg_hi:[0,0,1]
    v_exp_f32 v12, v12
    v_exp_f32 v28, v28
    v_exp_f32 v44, v44
    v_exp_f32 v60, v60
    v_exp_f32 v13, v13
    v_exp_f32 v29, v29
    v_exp_f32 v45, v45
    v_exp_f32 v61, v61
    v_exp_f32 v14, v14
    v_exp_f32 v30, v30
    v_exp_f32 v46, v46
    v_exp_f32 v62, v62
    v_exp_f32 v15, v15
    v_exp_f32 v31, v31
    v_exp_f32 v47, v47
    v_exp_f32 v63, v63
    v_cvt_pk_bf16_f32 v12, v12, v13
    v_cvt_pk_bf16_f32 v28, v28, v29
    v_cvt_pk_bf16_f32 v44, v44, v45
    v_cvt_pk_bf16_f32 v60, v60, v61
    v_cvt_pk_bf16_f32 v13, v14, v15
    v_cvt_pk_bf16_f32 v29, v30, v31
    v_cvt_pk_bf16_f32 v45, v46, v47
    v_cvt_pk_bf16_f32 v61, v62, v63
    v_and_b32 v10, v12, v138
    v_and_b32 v26, v28, v138
    v_and_b32 v42, v44, v138
    v_and_b32 v58, v60, v138
    v_and_b32 v11, v13, v139
    v_and_b32 v27, v29, v139
    v_and_b32 v43, v45, v139
    v_and_b32 v59, v61, v139
    v_xor_b32 v8, v12, v10
    v_xor_b32 v24, v28, v26
    v_xor_b32 v40, v44, v42
    v_xor_b32 v56, v60, v58
    v_xor_b32 v9, v13, v11
    v_xor_b32 v25, v29, v27
    v_xor_b32 v41, v45, v43
    v_xor_b32 v57, v61, v59
    v_mfma_f32_16x16x32_bf16 v[16:19], v[112:115], v[8:11], 0
    v_mfma_f32_16x16x32_bf16 v[32:35], v[112:115], v[24:27], 0
    v_mfma_f32_16x16x32_bf16 v[48:51], v[112:115], v[40:43], 0
    v_mfma_f32_16x16x32_bf16 v[64:67], v[112:115], v[56:59], 0
    v_mfma_f32_16x16x32_bf16 v[12:15], v[140:143], v[8:11], 0
    v_mfma_f32_16x16x32_bf16 v[28:31], v[150:153], v[24:27], 0
    v_mfma_f32_16x16x32_bf16 v[44:47], v[142:145], v[40:43], 0
    v_mfma_f32_16x16x32_bf16 v[60:63], v[152:155], v[56:59], 0
    s_nop 0
    v_rcp_f32 v20, v16
    v_rcp_f32 v36, v32
    v_rcp_f32 v52, v48
    v_rcp_f32 v68, v64
    v_pk_mul_f32 v[12:13], v[12:13], v[20:21] op_sel_hi:[1,0]
    v_pk_mul_f32 v[28:29], v[28:29], v[36:37] op_sel_hi:[1,0]
    v_pk_mul_f32 v[44:45], v[44:45], v[52:53] op_sel_hi:[1,0]
    v_pk_mul_f32 v[60:61], v[60:61], v[68:69] op_sel_hi:[1,0]
    v_pk_mul_f32 v[14:15], v[14:15], v[20:21] op_sel_hi:[1,0]
    v_pk_mul_f32 v[30:31], v[30:31], v[36:37] op_sel_hi:[1,0]
    v_pk_mul_f32 v[46:47], v[46:47], v[52:53] op_sel_hi:[1,0]
    v_pk_mul_f32 v[62:63], v[62:63], v[68:69] op_sel_hi:[1,0]
    v_cvt_pk_bf16_f32 v94, v12, v13
    v_cvt_pk_bf16_f32 v96, v28, v29
    v_cvt_pk_bf16_f32 v98, v44, v45
    v_cvt_pk_bf16_f32 v100, v60, v61
    v_cvt_pk_bf16_f32 v95, v14, v15
    v_cvt_pk_bf16_f32 v97, v30, v31
    v_cvt_pk_bf16_f32 v99, v46, v47
    v_cvt_pk_bf16_f32 v101, v62, v63
    v_permlane16_swap_b32 v94, v96
    v_permlane16_swap_b32 v95, v97
    v_permlane16_swap_b32 v98, v100
    v_permlane16_swap_b32 v99, v101
    s_mov_b32 s52, 0
    buffer_store_dwordx4 v[94:97], v7, s[36:39], s52 offen sc1
    s_mov_b32 s52, 32768
    buffer_store_dwordx4 v[98:101], v7, s[36:39], s52 offen sc1
    v_mfma_f32_16x16x16_bf16 v[8:11], v[80:81], v[102:103], v[126:129]
    v_mfma_f32_16x16x16_bf16 v[24:27], v[82:83], v[104:105], v[126:129]
    v_mfma_f32_16x16x16_bf16 v[40:43], v[84:85], v[106:107], v[126:129]
    v_mfma_f32_16x16x16_bf16 v[56:59], v[86:87], v[108:109], v[126:129]
    v_mfma_f32_16x16x16_bf16 v[12:15], v[84:85], v[102:103], v[122:125]
    v_mfma_f32_16x16x16_bf16 v[28:31], v[86:87], v[104:105], v[122:125]
    v_mfma_f32_16x16x16_bf16 v[44:47], v[88:89], v[106:107], v[122:125]
    v_mfma_f32_16x16x16_bf16 v[60:63], v[90:91], v[108:109], v[122:125]
    s_nop 4
    v_max_f32 v12, v12, v8
    v_max_f32 v28, v28, v24
    v_max_f32 v44, v44, v40
    v_max_f32 v60, v60, v56
    v_max_f32 v13, v13, v9
    v_max_f32 v29, v29, v25
    v_max_f32 v45, v45, v41
    v_max_f32 v61, v61, v57
    v_max_f32 v14, v14, v10
    v_max_f32 v30, v30, v26
    v_max_f32 v46, v46, v42
    v_max_f32 v62, v62, v58
    v_max_f32 v15, v15, v11
    v_max_f32 v31, v31, v27
    v_max_f32 v47, v47, v43
    v_max_f32 v63, v63, v59
    v_max3_f32 v20, v12, v13, v14
    v_max3_f32 v36, v28, v29, v30
    v_max3_f32 v52, v44, v45, v46
    v_max3_f32 v68, v60, v61, v62
    v_max_f32 v20, v20, v15
    v_max_f32 v36, v36, v31
    v_max_f32 v52, v52, v47
    v_max_f32 v68, v68, v63
    v_mov_b32 v21, v20
    v_mov_b32 v37, v36
    v_mov_b32 v53, v52
    v_mov_b32 v69, v68
    v_permlane16_swap_b32 v20, v21
    v_permlane16_swap_b32 v36, v37
    v_permlane16_swap_b32 v52, v53
    v_permlane16_swap_b32 v68, v69
    v_max_f32 v20, v20, v21
    v_max_f32 v36, v36, v37
    v_max_f32 v52, v52, v53
    v_max_f32 v68, v68, v69
    v_mov_b32 v21, v20
    v_mov_b32 v37, v36
    v_mov_b32 v53, v52
    v_mov_b32 v69, v68
    v_permlane32_swap_b32 v20, v21
    v_permlane32_swap_b32 v36, v37
    v_permlane32_swap_b32 v52, v53
    v_permlane32_swap_b32 v68, v69
    v_max_f32 v20, v20, v21
    v_max_f32 v36, v36, v37
    v_max_f32 v52, v52, v53
    v_max_f32 v68, v68, v69
    v_mul_f32 v20, s70, v20
    v_mul_f32 v36, s70, v36
    v_mul_f32 v52, s70, v52
    v_mul_f32 v68, s70, v68
    v_pk_fma_f32 v[12:13], v[12:13], s[70:71], v[20:21] op_sel_hi:[1,1,0] neg_lo:[0,0,1] neg_hi:[0,0,1]
    v_pk_fma_f32 v[28:29], v[28:29], s[70:71], v[36:37] op_sel_hi:[1,1,0] neg_lo:[0,0,1] neg_hi:[0,0,1]
    v_pk_fma_f32 v[44:45], v[44:45], s[70:71], v[52:53] op_sel_hi:[1,1,0] neg_lo:[0,0,1] neg_hi:[0,0,1]
    v_pk_fma_f32 v[60:61], v[60:61], s[70:71], v[68:69] op_sel_hi:[1,1,0] neg_lo:[0,0,1] neg_hi:[0,0,1]
    v_pk_fma_f32 v[14:15], v[14:15], s[70:71], v[20:21] op_sel_hi:[1,1,0] neg_lo:[0,0,1] neg_hi:[0,0,1]
    v_pk_fma_f32 v[30:31], v[30:31], s[70:71], v[36:37] op_sel_hi:[1,1,0] neg_lo:[0,0,1] neg_hi:[0,0,1]
    v_pk_fma_f32 v[46:47], v[46:47], s[70:71], v[52:53] op_sel_hi:[1,1,0] neg_lo:[0,0,1] neg_hi:[0,0,1]
    v_pk_fma_f32 v[62:63], v[62:63], s[70:71], v[68:69] op_sel_hi:[1,1,0] neg_lo:[0,0,1] neg_hi:[0,0,1]
    v_exp_f32 v12, v12
    v_exp_f32 v28, v28
    v_exp_f32 v44, v44
    v_exp_f32 v60, v60
    v_exp_f32 v13, v13
    v_exp_f32 v29, v29
    v_exp_f32 v45, v45
    v_exp_f32 v61, v61
    v_exp_f32 v14, v14
    v_exp_f32 v30, v30
    v_exp_f32 v46, v46
    v_exp_f32 v62, v62
    v_exp_f32 v15, v15
    v_exp_f32 v31, v31
    v_exp_f32 v47, v47
    v_exp_f32 v63, v63
    v_cvt_pk_bf16_f32 v12, v12, v13
    v_cvt_pk_bf16_f32 v28, v28, v29
    v_cvt_pk_bf16_f32 v44, v44, v45
    v_cvt_pk_bf16_f32 v60, v60, v61
    v_cvt_pk_bf16_f32 v13, v14, v15
    v_cvt_pk_bf16_f32 v29, v30, v31
    v_cvt_pk_bf16_f32 v45, v46, v47
    v_cvt_pk_bf16_f32 v61, v62, v63
    v_and_b32 v10, v12, v138
    v_and_b32 v26, v28, v138
    v_and_b32 v42, v44, v138
    v_and_b32 v58, v60, v138
    v_and_b32 v11, v13, v139
    v_and_b32 v27, v29, v139
    v_and_b32 v43, v45, v139
    v_and_b32 v59, v61, v139
    v_xor_b32 v8, v12, v10
    v_xor_b32 v24, v28, v26
    v_xor_b32 v40, v44, v42
    v_xor_b32 v56, v60, v58
    v_xor_b32 v9, v13, v11
    v_xor_b32 v25, v29, v27
    v_xor_b32 v41, v45, v43
    v_xor_b32 v57, v61, v59
    v_mfma_f32_16x16x32_bf16 v[16:19], v[112:115], v[8:11], 0
    v_mfma_f32_16x16x32_bf16 v[32:35], v[112:115], v[24:27], 0
    v_mfma_f32_16x16x32_bf16 v[48:51], v[112:115], v[40:43], 0
    v_mfma_f32_16x16x32_bf16 v[64:67], v[112:115], v[56:59], 0
    v_mfma_f32_16x16x32_bf16 v[12:15], v[144:147], v[8:11], 0
    v_mfma_f32_16x16x32_bf16 v[28:31], v[154:157], v[24:27], 0
    v_mfma_f32_16x16x32_bf16 v[44:47], v[146:149], v[40:43], 0
    v_mfma_f32_16x16x32_bf16 v[60:63], v[156:159], v[56:59], 0
    s_nop 0
    v_rcp_f32 v20, v16
    v_rcp_f32 v36, v32
    v_rcp_f32 v52, v48
    v_rcp_f32 v68, v64
    v_pk_mul_f32 v[12:13], v[12:13], v[20:21] op_sel_hi:[1,0]
    v_pk_mul_f32 v[28:29], v[28:29], v[36:37] op_sel_hi:[1,0]
    v_pk_mul_f32 v[44:45], v[44:45], v[52:53] op_sel_hi:[1,0]
    v_pk_mul_f32 v[60:61], v[60:61], v[68:69] op_sel_hi:[1,0]
    v_pk_mul_f32 v[14:15], v[14:15], v[20:21] op_sel_hi:[1,0]
    v_pk_mul_f32 v[30:31], v[30:31], v[36:37] op_sel_hi:[1,0]
    v_pk_mul_f32 v[46:47], v[46:47], v[52:53] op_sel_hi:[1,0]
    v_pk_mul_f32 v[62:63], v[62:63], v[68:69] op_sel_hi:[1,0]
    v_cvt_pk_bf16_f32 v102, v12, v13
    v_cvt_pk_bf16_f32 v104, v28, v29
    v_cvt_pk_bf16_f32 v106, v44, v45
    v_cvt_pk_bf16_f32 v108, v60, v61
    v_cvt_pk_bf16_f32 v103, v14, v15
    v_cvt_pk_bf16_f32 v105, v30, v31
    v_cvt_pk_bf16_f32 v107, v46, v47
    v_cvt_pk_bf16_f32 v109, v62, v63
    v_permlane16_swap_b32 v102, v104
    v_permlane16_swap_b32 v103, v105
    v_permlane16_swap_b32 v106, v108
    v_permlane16_swap_b32 v107, v109
    s_mov_b32 s52, 65536
    buffer_store_dwordx4 v[102:105], v7, s[36:39], s52 offen sc1
    s_mov_b32 s52, 98304
    buffer_store_dwordx4 v[106:109], v7, s[36:39], s52 offen sc1
    s_branch L_p2wait
L_p2wait:
    s_cmp_ge_u32 s47, 4
    s_cbranch_scc1 L_p2load
    s_waitcnt vmcnt(0)
    s_barrier
    v_and_b32 v1, 15, v0
    v_lshrrev_b32 v2, 4, v0
    v_bfe_u32 v3, v0, 2, 2
    v_and_b32 v4, 3, v0
    v_and_b32 v5, 1, v2
    v_lshl_or_b32 v6, v5, 2, v3
    v_lshlrev_b32 v6, 5, v6
    v_lshl_add_u32 v6, v4, 3, v6
    v_lshrrev_b32 v7, 1, v2
    v_lshlrev_b32 v7, 3, v7
    v_lshl_add_u32 v7, v5, 4, v7
    v_add_u32 v7, v7, v3
    v_lshl_add_u32 v6, v7, 8, v6
    v_add_u32 v6, 32768, v6
    s_lshl_b32 s52, s47, 6
    v_xor_b32 v72, s52, v6
    v_xor_b32 v73, 32, v72
    v_add_u32 v74, 0x10000, v72
    v_add_u32 v75, 0x10000, v73
    ds_read_b64_tr_b16 a[0:1], v72 offset:0
    ds_read_b64_tr_b16 a[2:3], v72 offset:1024
    ds_read_b64_tr_b16 a[64:65], v73 offset:0
    ds_read_b64_tr_b16 a[66:67], v73 offset:1024
    ds_read_b64_tr_b16 a[4:5], v72 offset:8192
    ds_read_b64_tr_b16 a[6:7], v72 offset:9216
    ds_read_b64_tr_b16 a[68:69], v73 offset:8192
    ds_read_b64_tr_b16 a[70:71], v73 offset:9216
    ds_read_b64_tr_b16 a[8:9], v72 offset:16384
    ds_read_b64_tr_b16 a[10:11], v72 offset:17408
    ds_read_b64_tr_b16 a[72:73], v73 offset:16384
    ds_read_b64_tr_b16 a[74:75], v73 offset:17408
    ds_read_b64_tr_b16 a[12:13], v72 offset:24576
    ds_read_b64_tr_b16 a[14:15], v72 offset:25600
    ds_read_b64_tr_b16 a[76:77], v73 offset:24576
    ds_read_b64_tr_b16 a[78:79], v73 offset:25600
    ds_read_b64_tr_b16 a[16:17], v72 offset:32768
    ds_read_b64_tr_b16 a[18:19], v72 offset:33792
    ds_read_b64_tr_b16 a[80:81], v73 offset:32768
    ds_read_b64_tr_b16 a[82:83], v73 offset:33792
    ds_read_b64_tr_b16 a[20:21], v72 offset:40960
    ds_read_b64_tr_b16 a[22:23], v72 offset:41984
    ds_read_b64_tr_b16 a[84:85], v73 offset:40960
    ds_read_b64_tr_b16 a[86:87], v73 offset:41984
    ds_read_b64_tr_b16 a[24:25], v72 offset:49152
    ds_read_b64_tr_b16 a[26:27], v72 offset:50176
    ds_read_b64_tr_b16 a[88:89], v73 offset:49152
    ds_read_b64_tr_b16 a[90:91], v73 offset:50176
    ds_read_b64_tr_b16 a[28:29], v72 offset:57344
    ds_read_b64_tr_b16 a[30:31], v72 offset:58368
    ds_read_b64_tr_b16 a[92:93], v73 offset:57344
    ds_read_b64_tr_b16 a[94:95], v73 offset:58368
    ds_read_b64_tr_b16 a[32:33], v74 offset:0
    ds_read_b64_tr_b16 a[34:35], v74 offset:1024
    ds_read_b64_tr_b16 v[112:113], v75 offset:0
    ds_read_b64_tr_b16 v[114:115], v75 offset:1024
    ds_read_b64_tr_b16 a[36:37], v74 offset:8192
    ds_read_b64_tr_b16 a[38:39], v74 offset:9216
    ds_read_b64_tr_b16 v[116:117], v75 offset:8192
    ds_read_b64_tr_b16 v[118:119], v75 offset:9216
    ds_read_b64_tr_b16 a[40:41], v74 offset:16384
    ds_read_b64_tr_b16 a[42:43], v74 offset:17408
    ds_read_b64_tr_b16 v[120:121], v75 offset:16384
    ds_read_b64_tr_b16 v[122:123], v75 offset:17408
    ds_read_b64_tr_b16 a[44:45], v74 offset:24576
    ds_read_b64_tr_b16 a[46:47], v74 offset:25600
    ds_read_b64_tr_b16 v[124:125], v75 offset:24576
    ds_read_b64_tr_b16 v[126:127], v75 offset:25600
    ds_read_b64_tr_b16 a[48:49], v74 offset:32768
    ds_read_b64_tr_b16 a[50:51], v74 offset:33792
    ds_read_b64_tr_b16 v[128:129], v75 offset:32768
    ds_read_b64_tr_b16 v[130:131], v75 offset:33792
    ds_read_b64_tr_b16 a[52:53], v74 offset:40960
    ds_read_b64_tr_b16 a[54:55], v74 offset:41984
    ds_read_b64_tr_b16 v[132:133], v75 offset:40960
    ds_read_b64_tr_b16 v[134:135], v75 offset:41984
    ds_read_b64_tr_b16 a[56:57], v74 offset:49152
    ds_read_b64_tr_b16 a[58:59], v74 offset:50176
    ds_read_b64_tr_b16 v[136:137], v75 offset:49152
    ds_read_b64_tr_b16 v[138:139], v75 offset:50176
    ds_read_b64_tr_b16 a[60:61], v74 offset:57344
    ds_read_b64_tr_b16 a[62:63], v74 offset:58368
    ds_read_b64_tr_b16 v[140:141], v75 offset:57344
    ds_read_b64_tr_b16 v[142:143], v75 offset:58368
    s_lshl_b32 s54, s48, 17
    s_lshl_b32 s55, s44, 10
    s_add_u32 s54, s54, s55
    s_lshl_b32 s55, s49, 8
    s_add_u32 s54, s54, s55
    s_lshl_b32 s55, s47, 6
    s_add_u32 s54, s54, s55
    v_lshlrev_b32 v3, 12, v1
    v_and_b32 v4, 1, v2
    v_lshl_add_u32 v3, v4, 5, v3
    v_lshrrev_b32 v4, 1, v2
    v_lshl_add_u32 v3, v4, 4, v3
    v_add_u32 v76, s54, v3
    v_lshlrev_b32 v77, 4, v0
    s_mov_b32 s55, 2048
    s_mov_b32 s56, 0x10000
    s_mov_b32 s57, 0x10800
    s_waitcnt lgkmcnt(0)
    s_barrier
    s_barrier
    ds_read_b128 v[40:43], v77 offset:0
    ds_read_b128 v[44:47], v77 offset:1024
    ds_read_b128 v[48:51], v77 offset:2048
    s_waitcnt lgkmcnt(2)
    v_mfma_f32_16x16x32_bf16 v[8:11], a[0:3], v[40:43], 0
    ds_read_b128 v[52:55], v77 offset:3072
    v_mfma_f32_16x16x32_bf16 v[12:15], a[64:67], v[40:43], 0
    s_waitcnt lgkmcnt(2)
    v_mfma_f32_16x16x32_bf16 v[8:11], a[4:7], v[44:47], v[8:11]
    ds_read_b128 v[40:43], v77 offset:4096
    v_mfma_f32_16x16x32_bf16 v[12:15], a[68:71], v[44:47], v[12:15]
    s_waitcnt lgkmcnt(2)
    v_mfma_f32_16x16x32_bf16 v[8:11], a[8:11], v[48:51], v[8:11]
    ds_read_b128 v[44:47], v77 offset:5120
    v_mfma_f32_16x16x32_bf16 v[12:15], a[72:75], v[48:51], v[12:15]
    s_waitcnt lgkmcnt(2)
    v_mfma_f32_16x16x32_bf16 v[8:11], a[12:15], v[52:55], v[8:11]
    ds_read_b128 v[48:51], v77 offset:6144
    v_mfma_f32_16x16x32_bf16 v[12:15], a[76:79], v[52:55], v[12:15]
    s_waitcnt lgkmcnt(2)
    v_mfma_f32_16x16x32_bf16 v[8:11], a[16:19], v[40:43], v[8:11]
    ds_read_b128 v[52:55], v77 offset:7168
    v_mfma_f32_16x16x32_bf16 v[12:15], a[80:83], v[40:43], v[12:15]
    s_waitcnt lgkmcnt(2)
    v_mfma_f32_16x16x32_bf16 v[8:11], a[20:23], v[44:47], v[8:11]
    ds_read_b128 v[40:43], v77 offset:8192
    v_mfma_f32_16x16x32_bf16 v[12:15], a[84:87], v[44:47], v[12:15]
    s_waitcnt lgkmcnt(2)
    v_mfma_f32_16x16x32_bf16 v[8:11], a[24:27], v[48:51], v[8:11]
    ds_read_b128 v[44:47], v77 offset:9216
    v_mfma_f32_16x16x32_bf16 v[12:15], a[88:91], v[48:51], v[12:15]
    s_waitcnt lgkmcnt(2)
    v_mfma_f32_16x16x32_bf16 v[8:11], a[28:31], v[52:55], v[8:11]
    ds_read_b128 v[48:51], v77 offset:10240
    v_mfma_f32_16x16x32_bf16 v[12:15], a[92:95], v[52:55], v[12:15]
    s_waitcnt lgkmcnt(2)
    v_mfma_f32_16x16x32_bf16 v[8:11], a[32:35], v[40:43], v[8:11]
    ds_read_b128 v[52:55], v77 offset:11264
    v_mfma_f32_16x16x32_bf16 v[12:15], v[112:115], v[40:43], v[12:15]
    s_waitcnt lgkmcnt(2)
    v_mfma_f32_16x16x32_bf16 v[8:11], a[36:39], v[44:47], v[8:11]
    ds_read_b128 v[40:43], v77 offset:12288
    v_mfma_f32_16x16x32_bf16 v[12:15], v[116:119], v[44:47], v[12:15]
    s_waitcnt lgkmcnt(2)
    v_mfma_f32_16x16x32_bf16 v[8:11], a[40:43], v[48:51], v[8:11]
    ds_read_b128 v[44:47], v77 offset:13312
    v_mfma_f32_16x16x32_bf16 v[12:15], v[120:123], v[48:51], v[12:15]
    s_waitcnt lgkmcnt(2)
    v_mfma_f32_16x16x32_bf16 v[8:11], a[44:47], v[52:55], v[8:11]
    ds_read_b128 v[48:51], v77 offset:14336
    v_mfma_f32_16x16x32_bf16 v[12:15], v[124:127], v[52:55], v[12:15]
    s_waitcnt lgkmcnt(2)
    v_mfma_f32_16x16x32_bf16 v[8:11], a[48:51], v[40:43], v[8:11]
    ds_read_b128 v[52:55], v77 offset:15360
    v_mfma_f32_16x16x32_bf16 v[12:15], v[128:131], v[40:43], v[12:15]
    s_barrier
    s_waitcnt lgkmcnt(2)
    v_mfma_f32_16x16x32_bf16 v[8:11], a[52:55], v[44:47], v[8:11]
    ds_read_b128 v[40:43], v77 offset:16384
    v_mfma_f32_16x16x32_bf16 v[12:15], v[132:135], v[44:47], v[12:15]
    s_waitcnt lgkmcnt(2)
    v_mfma_f32_16x16x32_bf16 v[8:11], a[56:59], v[48:51], v[8:11]
    ds_read_b128 v[44:47], v77 offset:17408
    v_mfma_f32_16x16x32_bf16 v[12:15], v[136:139], v[48:51], v[12:15]
    s_waitcnt lgkmcnt(2)
    v_mfma_f32_16x16x32_bf16 v[8:11], a[60:63], v[52:55], v[8:11]
    ds_read_b128 v[48:51], v77 offset:18432
    v_mfma_f32_16x16x32_bf16 v[12:15], v[140:143], v[52:55], v[12:15]
    s_waitcnt lgkmcnt(2)
    v_mfma_f32_16x16x32_bf16 v[16:19], a[0:3], v[40:43], 0
    ds_read_b128 v[52:55], v77 offset:19456
    v_mfma_f32_16x16x32_bf16 v[20:23], a[64:67], v[40:43], 0
    s_waitcnt lgkmcnt(2)
    v_mfma_f32_16x16x32_bf16 v[16:19], a[4:7], v[44:47], v[16:19]
    ds_read_b128 v[40:43], v77 offset:20480
    v_mfma_f32_16x16x32_bf16 v[20:23], a[68:71], v[44:47], v[20:23]
    s_waitcnt lgkmcnt(2)
    v_mfma_f32_16x16x32_bf16 v[16:19], a[8:11], v[48:51], v[16:19]
    ds_read_b128 v[44:47], v77 offset:21504
    v_mfma_f32_16x16x32_bf16 v[20:23], a[72:75], v[48:51], v[20:23]
    v_cvt_pk_bf16_f32 v80, v8, v9
    s_waitcnt lgkmcnt(2)
    v_mfma_f32_16x16x32_bf16 v[16:19], a[12:15], v[52:55], v[16:19]
    ds_read_b128 v[48:51], v77 offset:22528
    v_mfma_f32_16x16x32_bf16 v[20:23], a[76:79], v[52:55], v[20:23]
    v_cvt_pk_bf16_f32 v81, v10, v11
    s_waitcnt lgkmcnt(2)
    v_mfma_f32_16x16x32_bf16 v[16:19], a[16:19], v[40:43], v[16:19]
    ds_read_b128 v[52:55], v77 offset:23552
    v_mfma_f32_16x16x32_bf16 v[20:23], a[80:83], v[40:43], v[20:23]
    v_cvt_pk_bf16_f32 v82, v12, v13
    s_waitcnt lgkmcnt(2)
    v_mfma_f32_16x16x32_bf16 v[16:19], a[20:23], v[44:47], v[16:19]
    ds_read_b128 v[40:43], v77 offset:24576
    v_mfma_f32_16x16x32_bf16 v[20:23], a[84:87], v[44:47], v[20:23]
    v_cvt_pk_bf16_f32 v83, v14, v15
    s_waitcnt lgkmcnt(2)
    v_mfma_f32_16x16x32_bf16 v[16:19], a[24:27], v[48:51], v[16:19]
    ds_read_b128 v[44:47], v77 offset:25600
    v_mfma_f32_16x16x32_bf16 v[20:23], a[88:91], v[48:51], v[20:23]
    v_permlane16_swap_b32 v80, v82
    s_waitcnt lgkmcnt(2)
    v_mfma_f32_16x16x32_bf16 v[16:19], a[28:31], v[52:55], v[16:19]
    ds_read_b128 v[48:51], v77 offset:26624
    v_mfma_f32_16x16x32_bf16 v[20:23], a[92:95], v[52:55], v[20:23]
    v_permlane16_swap_b32 v81, v83
    s_waitcnt lgkmcnt(2)
    v_mfma_f32_16x16x32_bf16 v[16:19], a[32:35], v[40:43], v[16:19]
    ds_read_b128 v[52:55], v77 offset:27648
    v_mfma_f32_16x16x32_bf16 v[20:23], v[112:115], v[40:43], v[20:23]
    buffer_store_dwordx4 v[80:83], v76, s[32:35], 0 offen sc1
    s_waitcnt lgkmcnt(2)
    v_mfma_f32_16x16x32_bf16 v[16:19], a[36:39], v[44:47], v[16:19]
    ds_read_b128 v[40:43], v77 offset:28672
    v_mfma_f32_16x16x32_bf16 v[20:23], v[116:119], v[44:47], v[20:23]
    s_waitcnt lgkmcnt(2)
    v_mfma_f32_16x16x32_bf16 v[16:19], a[40:43], v[48:51], v[16:19]
    ds_read_b128 v[44:47], v77 offset:29696
    v_mfma_f32_16x16x32_bf16 v[20:23], v[120:123], v[48:51], v[20:23]
    s_waitcnt lgkmcnt(2)
    v_mfma_f32_16x16x32_bf16 v[16:19], a[44:47], v[52:55], v[16:19]
    ds_read_b128 v[48:51], v77 offset:30720
    v_mfma_f32_16x16x32_bf16 v[20:23], v[124:127], v[52:55], v[20:23]
    s_waitcnt lgkmcnt(2)
    v_mfma_f32_16x16x32_bf16 v[16:19], a[48:51], v[40:43], v[16:19]
    ds_read_b128 v[52:55], v77 offset:31744
    v_mfma_f32_16x16x32_bf16 v[20:23], v[128:131], v[40:43], v[20:23]
    s_barrier
    s_waitcnt lgkmcnt(2)
    v_mfma_f32_16x16x32_bf16 v[16:19], a[52:55], v[44:47], v[16:19]
    ds_read_b128 v[40:43], v77 offset:32768
    v_mfma_f32_16x16x32_bf16 v[20:23], v[132:135], v[44:47], v[20:23]
    s_waitcnt lgkmcnt(2)
    v_mfma_f32_16x16x32_bf16 v[16:19], a[56:59], v[48:51], v[16:19]
    ds_read_b128 v[44:47], v77 offset:33792
    v_mfma_f32_16x16x32_bf16 v[20:23], v[136:139], v[48:51], v[20:23]
    s_waitcnt lgkmcnt(2)
    v_mfma_f32_16x16x32_bf16 v[16:19], a[60:63], v[52:55], v[16:19]
    ds_read_b128 v[48:51], v77 offset:34816
    v_mfma_f32_16x16x32_bf16 v[20:23], v[140:143], v[52:55], v[20:23]
    s_waitcnt lgkmcnt(2)
    v_mfma_f32_16x16x32_bf16 v[8:11], a[0:3], v[40:43], 0
    ds_read_b128 v[52:55], v77 offset:35840
    v_mfma_f32_16x16x32_bf16 v[12:15], a[64:67], v[40:43], 0
    s_waitcnt lgkmcnt(2)
    v_mfma_f32_16x16x32_bf16 v[8:11], a[4:7], v[44:47], v[8:11]
    ds_read_b128 v[40:43], v77 offset:36864
    v_mfma_f32_16x16x32_bf16 v[12:15], a[68:71], v[44:47], v[12:15]
    s_waitcnt lgkmcnt(2)
    v_mfma_f32_16x16x32_bf16 v[8:11], a[8:11], v[48:51], v[8:11]
    ds_read_b128 v[44:47], v77 offset:37888
    v_mfma_f32_16x16x32_bf16 v[12:15], a[72:75], v[48:51], v[12:15]
    v_cvt_pk_bf16_f32 v84, v16, v17
    s_waitcnt lgkmcnt(2)
    v_mfma_f32_16x16x32_bf16 v[8:11], a[12:15], v[52:55], v[8:11]
    ds_read_b128 v[48:51], v77 offset:38912
    v_mfma_f32_16x16x32_bf16 v[12:15], a[76:79], v[52:55], v[12:15]
    v_cvt_pk_bf16_f32 v85, v18, v19
    s_waitcnt lgkmcnt(2)
    v_mfma_f32_16x16x32_bf16 v[8:11], a[16:19], v[40:43], v[8:11]
    ds_read_b128 v[52:55], v77 offset:39936
    v_mfma_f32_16x16x32_bf16 v[12:15], a[80:83], v[40:43], v[12:15]
    v_cvt_pk_bf16_f32 v86, v20, v21
    s_waitcnt lgkmcnt(2)
    v_mfma_f32_16x16x32_bf16 v[8:11], a[20:23], v[44:47], v[8:11]
    ds_read_b128 v[40:43], v77 offset:40960
    v_mfma_f32_16x16x32_bf16 v[12:15], a[84:87], v[44:47], v[12:15]
    v_cvt_pk_bf16_f32 v87, v22, v23
    s_waitcnt lgkmcnt(2)
    v_mfma_f32_16x16x32_bf16 v[8:11], a[24:27], v[48:51], v[8:11]
    ds_read_b128 v[44:47], v77 offset:41984
    v_mfma_f32_16x16x32_bf16 v[12:15], a[88:91], v[48:51], v[12:15]
    v_permlane16_swap_b32 v84, v86
    s_waitcnt lgkmcnt(2)
    v_mfma_f32_16x16x32_bf16 v[8:11], a[28:31], v[52:55], v[8:11]
    ds_read_b128 v[48:51], v77 offset:43008
    v_mfma_f32_16x16x32_bf16 v[12:15], a[92:95], v[52:55], v[12:15]
    v_permlane16_swap_b32 v85, v87
    s_waitcnt lgkmcnt(2)
    v_mfma_f32_16x16x32_bf16 v[8:11], a[32:35], v[40:43], v[8:11]
    ds_read_b128 v[52:55], v77 offset:44032
    v_mfma_f32_16x16x32_bf16 v[12:15], v[112:115], v[40:43], v[12:15]
    buffer_store_dwordx4 v[84:87], v76, s[32:35], s55 offen sc1
    s_waitcnt lgkmcnt(2)
    v_mfma_f32_16x16x32_bf16 v[8:11], a[36:39], v[44:47], v[8:11]
    ds_read_b128 v[40:43], v77 offset:45056
    v_mfma_f32_16x16x32_bf16 v[12:15], v[116:119], v[44:47], v[12:15]
    s_waitcnt lgkmcnt(2)
    v_mfma_f32_16x16x32_bf16 v[8:11], a[40:43], v[48:51], v[8:11]
    ds_read_b128 v[44:47], v77 offset:46080
    v_mfma_f32_16x16x32_bf16 v[12:15], v[120:123], v[48:51], v[12:15]
    s_waitcnt lgkmcnt(2)
    v_mfma_f32_16x16x32_bf16 v[8:11], a[44:47], v[52:55], v[8:11]
    ds_read_b128 v[48:51], v77 offset:47104
    v_mfma_f32_16x16x32_bf16 v[12:15], v[124:127], v[52:55], v[12:15]
    s_waitcnt lgkmcnt(2)
    v_mfma_f32_16x16x32_bf16 v[8:11], a[48:51], v[40:43], v[8:11]
    ds_read_b128 v[52:55], v77 offset:48128
    v_mfma_f32_16x16x32_bf16 v[12:15], v[128:131], v[40:43], v[12:15]
    s_barrier
    s_waitcnt lgkmcnt(2)
    v_mfma_f32_16x16x32_bf16 v[8:11], a[52:55], v[44:47], v[8:11]
    ds_read_b128 v[40:43], v77 offset:49152
    v_mfma_f32_16x16x32_bf16 v[12:15], v[132:135], v[44:47], v[12:15]
    s_waitcnt lgkmcnt(2)
    v_mfma_f32_16x16x32_bf16 v[8:11], a[56:59], v[48:51], v[8:11]
    ds_read_b128 v[44:47], v77 offset:50176
    v_mfma_f32_16x16x32_bf16 v[12:15], v[136:139], v[48:51], v[12:15]
    s_waitcnt lgkmcnt(2)
    v_mfma_f32_16x16x32_bf16 v[8:11], a[60:63], v[52:55], v[8:11]
    ds_read_b128 v[48:51], v77 offset:51200
    v_mfma_f32_16x16x32_bf16 v[12:15], v[140:143], v[52:55], v[12:15]
    s_waitcnt lgkmcnt(2)
    v_mfma_f32_16x16x32_bf16 v[16:19], a[0:3], v[40:43], 0
    ds_read_b128 v[52:55], v77 offset:52224
    v_mfma_f32_16x16x32_bf16 v[20:23], a[64:67], v[40:43], 0
    s_waitcnt lgkmcnt(2)
    v_mfma_f32_16x16x32_bf16 v[16:19], a[4:7], v[44:47], v[16:19]
    ds_read_b128 v[40:43], v77 offset:53248
    v_mfma_f32_16x16x32_bf16 v[20:23], a[68:71], v[44:47], v[20:23]
    s_waitcnt lgkmcnt(2)
    v_mfma_f32_16x16x32_bf16 v[16:19], a[8:11], v[48:51], v[16:19]
    ds_read_b128 v[44:47], v77 offset:54272
    v_mfma_f32_16x16x32_bf16 v[20:23], a[72:75], v[48:51], v[20:23]
    v_cvt_pk_bf16_f32 v80, v8, v9
    s_waitcnt lgkmcnt(2)
    v_mfma_f32_16x16x32_bf16 v[16:19], a[12:15], v[52:55], v[16:19]
    ds_read_b128 v[48:51], v77 offset:55296
    v_mfma_f32_16x16x32_bf16 v[20:23], a[76:79], v[52:55], v[20:23]
    v_cvt_pk_bf16_f32 v81, v10, v11
    s_waitcnt lgkmcnt(2)
    v_mfma_f32_16x16x32_bf16 v[16:19], a[16:19], v[40:43], v[16:19]
    ds_read_b128 v[52:55], v77 offset:56320
    v_mfma_f32_16x16x32_bf16 v[20:23], a[80:83], v[40:43], v[20:23]
    v_cvt_pk_bf16_f32 v82, v12, v13
    s_waitcnt lgkmcnt(2)
    v_mfma_f32_16x16x32_bf16 v[16:19], a[20:23], v[44:47], v[16:19]
    ds_read_b128 v[40:43], v77 offset:57344
    v_mfma_f32_16x16x32_bf16 v[20:23], a[84:87], v[44:47], v[20:23]
    v_cvt_pk_bf16_f32 v83, v14, v15
    s_waitcnt lgkmcnt(2)
    v_mfma_f32_16x16x32_bf16 v[16:19], a[24:27], v[48:51], v[16:19]
    ds_read_b128 v[44:47], v77 offset:58368
    v_mfma_f32_16x16x32_bf16 v[20:23], a[88:91], v[48:51], v[20:23]
    v_permlane16_swap_b32 v80, v82
    s_waitcnt lgkmcnt(2)
    v_mfma_f32_16x16x32_bf16 v[16:19], a[28:31], v[52:55], v[16:19]
    ds_read_b128 v[48:51], v77 offset:59392
    v_mfma_f32_16x16x32_bf16 v[20:23], a[92:95], v[52:55], v[20:23]
    v_permlane16_swap_b32 v81, v83
    s_waitcnt lgkmcnt(2)
    v_mfma_f32_16x16x32_bf16 v[16:19], a[32:35], v[40:43], v[16:19]
    ds_read_b128 v[52:55], v77 offset:60416
    v_mfma_f32_16x16x32_bf16 v[20:23], v[112:115], v[40:43], v[20:23]
    buffer_store_dwordx4 v[80:83], v76, s[32:35], s56 offen sc1
    s_waitcnt lgkmcnt(2)
    v_mfma_f32_16x16x32_bf16 v[16:19], a[36:39], v[44:47], v[16:19]
    ds_read_b128 v[40:43], v77 offset:61440
    v_mfma_f32_16x16x32_bf16 v[20:23], v[116:119], v[44:47], v[20:23]
    s_waitcnt lgkmcnt(2)
    v_mfma_f32_16x16x32_bf16 v[16:19], a[40:43], v[48:51], v[16:19]
    ds_read_b128 v[44:47], v77 offset:62464
    v_mfma_f32_16x16x32_bf16 v[20:23], v[120:123], v[48:51], v[20:23]
    s_waitcnt lgkmcnt(2)
    v_mfma_f32_16x16x32_bf16 v[16:19], a[44:47], v[52:55], v[16:19]
    ds_read_b128 v[48:51], v77 offset:63488
    v_mfma_f32_16x16x32_bf16 v[20:23], v[124:127], v[52:55], v[20:23]
    s_waitcnt lgkmcnt(2)
    v_mfma_f32_16x16x32_bf16 v[16:19], a[48:51], v[40:43], v[16:19]
    ds_read_b128 v[52:55], v77 offset:64512
    v_mfma_f32_16x16x32_bf16 v[20:23], v[128:131], v[40:43], v[20:23]
    s_waitcnt lgkmcnt(2)
    v_mfma_f32_16x16x32_bf16 v[16:19], a[52:55], v[44:47], v[16:19]
    v_mfma_f32_16x16x32_bf16 v[20:23], v[132:135], v[44:47], v[20:23]
    s_waitcnt lgkmcnt(1)
    v_mfma_f32_16x16x32_bf16 v[16:19], a[56:59], v[48:51], v[16:19]
    v_mfma_f32_16x16x32_bf16 v[20:23], v[136:139], v[48:51], v[20:23]
    s_waitcnt lgkmcnt(0)
    v_mfma_f32_16x16x32_bf16 v[16:19], a[60:63], v[52:55], v[16:19]
    v_mfma_f32_16x16x32_bf16 v[20:23], v[140:143], v[52:55], v[20:23]
    s_nop 6
    v_cvt_pk_bf16_f32 v84, v16, v17
    v_cvt_pk_bf16_f32 v85, v18, v19
    v_cvt_pk_bf16_f32 v86, v20, v21
    v_cvt_pk_bf16_f32 v87, v22, v23
    s_nop 0
    v_permlane16_swap_b32 v84, v86
    v_permlane16_swap_b32 v85, v87
    buffer_store_dwordx4 v[84:87], v76, s[32:35], s57 offen sc1
    s_branch L_fin
L_p2load:
    s_lshl_b32 s54, s48, 16
    s_lshl_b32 s52, s44, 21
    s_add_u32 s54, s54, s52
    s_lshl_b32 s65, s50, 12
    s_add_u32 s54, s54, s65
    s_add_u32 s54, s54, 0x100000
    v_lshl_add_u32 v8, v0, 4, s54
    s_lshl_b32 s56, s50, 11
    s_sub_u32 s54, s54, s56
    v_lshl_add_u32 v9, v0, 4, s54
    s_cmp_eq_u32 s47, 4
    s_cbranch_scc0 L_fl_12_x
    s_mov_b32 s66, 0
    s_lshr_b32 s52, s48, 1
    s_lshl_b32 s52, s52, 8
    s_lshl_b32 s53, s44, 12
    s_add_u32 s52, s52, s53
    v_and_b32 v60, 7, v0
    v_lshl_add_u32 v60, v60, 2, s52
    s_waitcnt vmcnt(0)
L_fl_12:
    buffer_load_dword v61, v60, s[36:39], 0 offen sc1
    s_waitcnt vmcnt(0)
    v_cmp_eq_u32 vcc, 1, v61
    s_nop 3
    s_cmp_eq_u64 vcc, -1
    s_cbranch_scc1 L_fl_12_x
    s_add_u32 s66, s66, 1
    s_cmp_gt_u32 s66, 100000
    s_cbranch_scc1 L_fl_12_x
    s_sleep 4
    s_branch L_fl_12
L_fl_12_x:
    s_barrier
    s_add_u32 m0, s65, 0
    s_mov_b32 s54, 0
    buffer_load_dwordx4 v8, s[36:39], s54 offen sc1 lds
    s_add_u32 m0, s65, 1024
    s_mov_b32 s54, 1024
    buffer_load_dwordx4 v8, s[36:39], s54 offen sc1 lds
    s_add_u32 m0, s65, 2048
    s_mov_b32 s54, 2048
    buffer_load_dwordx4 v8, s[36:39], s54 offen sc1 lds
    s_add_u32 m0, s65, 3072
    s_mov_b32 s54, 3072
    buffer_load_dwordx4 v8, s[36:39], s54 offen sc1 lds
    s_add_u32 m0, s65, 16384
    s_mov_b32 s54, 16384
    buffer_load_dwordx4 v8, s[36:39], s54 offen sc1 lds
    s_add_u32 m0, s65, 17408
    s_mov_b32 s54, 17408
    buffer_load_dwordx4 v8, s[36:39], s54 offen sc1 lds
    s_add_u32 m0, s65, 18432
    s_mov_b32 s54, 18432
    buffer_load_dwordx4 v8, s[36:39], s54 offen sc1 lds
    s_add_u32 m0, s65, 19456
    s_mov_b32 s54, 19456
    buffer_load_dwordx4 v8, s[36:39], s54 offen sc1 lds
    s_add_u32 m0, s65, 32768
    s_mov_b32 s54, 32768
    buffer_load_dwordx4 v8, s[36:39], s54 offen sc1 lds
    s_add_u32 m0, s65, 33792
    s_mov_b32 s54, 33792
    buffer_load_dwordx4 v8, s[36:39], s54 offen sc1 lds
    s_add_u32 m0, s65, 34816
    s_mov_b32 s54, 34816
    buffer_load_dwordx4 v8, s[36:39], s54 offen sc1 lds
    s_add_u32 m0, s65, 35840
    s_mov_b32 s54, 35840
    buffer_load_dwordx4 v8, s[36:39], s54 offen sc1 lds
    s_add_u32 m0, s65, 49152
    s_mov_b32 s54, 49152
    buffer_load_dwordx4 v8, s[36:39], s54 offen sc1 lds
    s_add_u32 m0, s65, 50176
    s_mov_b32 s54, 50176
    buffer_load_dwordx4 v8, s[36:39], s54 offen sc1 lds
    s_add_u32 m0, s65, 51200
    s_mov_b32 s54, 51200
    buffer_load_dwordx4 v8, s[36:39], s54 offen sc1 lds
    s_add_u32 m0, s65, 52224
    s_mov_b32 s54, 52224
    buffer_load_dwordx4 v8, s[36:39], s54 offen sc1 lds
    s_waitcnt vmcnt(12)
    s_barrier
    s_waitcnt vmcnt(8)
    s_barrier
    s_waitcnt vmcnt(4)
    s_barrier
    s_waitcnt vmcnt(0)
    s_barrier
L_fin:
L_end:
    s_endpgm
.section .rodata,"a"
.p2align 6
.amdhsa_kernel concat_heads__linear_attn_block__sliding_local_dilated__prompt_kernel
  .amdhsa_next_free_vgpr 256
  .amdhsa_next_free_sgpr 102
  .amdhsa_accum_offset 160
  .amdhsa_group_segment_fixed_size 0
  .amdhsa_kernarg_size 72
  .amdhsa_user_sgpr_count 2
  .amdhsa_user_sgpr_kernarg_segment_ptr 1
  .amdhsa_system_sgpr_workgroup_id_x 1
  .amdhsa_float_denorm_mode_32 3
.end_amdhsa_kernel
```
